```python
import torch

def _softmax(x, axis=-1):
    return torch.softmax(x, dim=axis)
def _gelu(x):
    return torch.nn.functional.gelu(x, approximate="tanh")
def _silu(x):
    return torch.nn.functional.silu(x)
def _sigmoid(x):
    return torch.sigmoid(x)
def _layernorm(x, axis=-1, eps=1e-5):
    m = x.mean(dim=axis, keepdim=True)
    v = x.var(dim=axis, keepdim=True, unbiased=False)
    return (x - m) / torch.sqrt(v + eps)
def _scatter_add(tgt, idx, src, axis=0):
    return tgt.clone().index_add_(axis, idx, src)
def _segment_sum(src, seg, n):
    out = torch.zeros((n,) + src.shape[1:], dtype=src.dtype)
    return out.index_add_(0, seg, src)
def _pad(x, pw):
    flat = tuple(v for pair in reversed(pw) for v in pair)
    return torch.nn.functional.pad(x, flat)

kernel_name = 'parallel_sum__gqa_block_cached__dense_activation_silu__decode'

def setup_inputs():

    _w = (lambda a: (lambda t: t.to(torch.bfloat16) if t.is_floating_point() else t)(torch.as_tensor(a)))
    def _A_setup():
        B, Sq, D = 4, 1, 512
        Hq, Hkv, Sk, Dh = 32, 8, 4096, 128
        assert Hq % Hkv == 0, (Hq, Hkv)
        return {
            "x": _w((lambda *s: torch.randn(*s, dtype=torch.bfloat16) * 0.05)(B, Sq, D)),
            "k_cache": _w((lambda *s: torch.randn(*s, dtype=torch.bfloat16) * 3.2)(B, Hkv, Sk, Dh)),
            "v_cache": _w((lambda *s: torch.randn(*s, dtype=torch.bfloat16) * 0.8)(B, Hkv, Sk, Dh)),
            "wq": _w((lambda *s: torch.randn(*s, dtype=torch.bfloat16) * 3.2)(D, Hq * Dh) * (D ** -0.5)),
            "wo": _w((lambda *s: torch.randn(*s, dtype=torch.bfloat16) * 0.8)(Hq * Dh, D) * ((Hq * Dh) ** -0.5)),
        }
    _A_in = _A_setup()

    def _B_setup():
        B, S, D, F = 4, 1, 512, 1792
        return {
            "x": _w((lambda *s: torch.randn(*s, dtype=torch.bfloat16) * 0.05)(B, S, D)),
            "w1": _w((lambda *s: torch.randn(*s, dtype=torch.bfloat16) * 3.2)(D, F) * (D ** -0.5)),
            "w2": _w((lambda *s: torch.randn(*s, dtype=torch.bfloat16) * 0.4)(F, D) * (F ** -0.5)),
        }
    _B_in = _B_setup()

    return {
        "A_x": _A_in["x"],
        "A_k_cache": _A_in["k_cache"],
        "A_v_cache": _A_in["v_cache"],
        "A_wq": _A_in["wq"],
        "A_wo": _A_in["wo"],
        "B_x": _B_in["x"],
        "B_w1": _B_in["w1"],
        "B_w2": _B_in["w2"],
    }

def reference(A_x, A_k_cache, A_v_cache, A_wq, A_wo, B_x, B_w1, B_w2):
    def _A_ref(x, k_cache, v_cache, wq, wo):
        B, Sq, D = x.shape
        Hq, Dh = 32, 128
        Hkv = k_cache.shape[1]
        rep = Hq // Hkv
        q = (lambda x, *d: x.permute(*d))((x @ wq).reshape(B, Sq, Hq, Dh), 0, 2, 1, 3)
        k = (lambda x, n, axis: torch.repeat_interleave(x, n, dim=axis))(k_cache, rep, axis=1)
        v = (lambda x, n, axis: torch.repeat_interleave(x, n, dim=axis))(v_cache, rep, axis=1)
        scores = torch.einsum("bhqd,bhkd->bhqk", q, k) * (Dh ** -0.5)
        p = _softmax(scores, axis=-1)
        o = torch.einsum("bhqk,bhkd->bhqd", p, v)
        return (lambda x, *d: x.permute(*d))(o, 0, 2, 1, 3).reshape(B, Sq, Hq * Dh) @ wo

    def _B_ref(x, w1, w2):
        h = torch.einsum("bsd,df->bsf", x, w1)
        h = _silu(h)
        out = torch.einsum("bsf,fd->bsd", h, w2)
        return out

    x = A_x
    xn = _layernorm(x, axis=-1)
    return x + _A_ref(xn, A_k_cache, A_v_cache, A_wq, A_wo) + _B_ref(xn, B_w1, B_w2)
```

```asm
; @launch grid=(256,1,1) block=(768,1,1) lds=16896
.amdgcn_target "amdgcn-amd-amdhsa--gfx950"
.text
.globl parallel_sum__gqa_block_cached__dense_activation_silu__decode_kernel
.p2align 8
.type parallel_sum__gqa_block_cached__dense_activation_silu__decode_kernel,@function
parallel_sum__gqa_block_cached__dense_activation_silu__decode_kernel:
    s_cmp_ge_u32 s2, 256
    s_cbranch_scc1 L_exit
    s_load_dwordx16 s[4:19], s[0:1], 0
    v_lshrrev_b32 v1, 6, v0
    v_and_b32 v0, 63, v0
    v_mov_b32 v6, 0
    v_readfirstlane_b32 s26, v1
    v_mov_b32 v7, 0
    v_lshlrev_b32 v2, 3, v0
    ds_write_b64 v2, v[6:7]
    v_mov_b32 v7, 1
    s_and_b32 s27, s2, 7
    s_lshr_b32 s28, s2, 3
    s_lshr_b32 s29, s28, 3
    s_and_b32 s30, s28, 7
    s_mov_b32 s50, 0x40000
    v_lshrrev_b32 v2, 4, v0
    v_and_b32 v3, 15, v0
    s_cmp_lt_u32 s26, 4
    s_cbranch_scc1 L_H
    s_lshl_b32 s44, s29, 3
    s_add_u32 s44, s44, s27
    s_lshl_b32 s44, s44, 20
    s_lshl_b32 s45, s30, 17
    s_add_u32 s44, s44, s45
    s_and_b32 s31, s26, 3
    s_lshl_b32 s45, s31, 8
    s_add_u32 s49, s44, s45
    s_mov_b32 s62, 0
    s_cmp_ge_u32 s26, 8
    s_cbranch_scc1 L_V
    v_lshlrev_b32 v4, 6, v2
    v_and_b32 v5, 3, v0
    v_lshl_add_u32 v4, v5, 4, v4
    v_bfe_u32 v5, v0, 2, 2
    v_lshl_add_u32 v36, v5, 8, v4
    v_bfe_u32 v5, v0, 2, 2
    v_lshl_add_u32 v1, v5, 12, v4
    s_waitcnt lgkmcnt(0)
    s_add_u32 s32, s6, s49
    s_addc_u32 s33, s7, 0
    s_mov_b32 s34, 0x20000
    s_mov_b32 s35, 0x20000
    buffer_load_dwordx4 v[40:43], v1, s[32:35], s62 offen offset:0 nt
    s_nop 0
    buffer_load_dwordx4 v[56:59], v1, s[32:35], s62 offen offset:1024 nt
    s_nop 0
    buffer_load_dwordx4 v[44:47], v1, s[32:35], s62 offen offset:2048 nt
    s_nop 0
    s_branch L_K1
L_H:
    s_load_dwordx4 s[20:23], s[0:1], 64
    s_load_dwordx2 s[24:25], s[0:1], 80
    s_setprio 2
    s_cmp_ge_u32 s26, 2
    s_cbranch_scc1 L_H23
    v_lshrrev_b32 v4, 3, v0
    v_and_b32 v5, 7, v0
    s_cmp_eq_u32 s26, 1
    s_cbranch_scc1 L_H1a
    v_lshlrev_b32 v1, 16, v4
    v_lshl_add_u32 v1, v5, 4, v1
    s_lshl_b32 s45, s29, 8
    s_lshl_b32 s46, s29, 20
    s_lshl_b32 s47, s27, 10
    s_add_u32 s46, s46, s47
    s_lshl_b32 s47, s30, 7
    s_add_u32 s46, s46, s47
    s_waitcnt lgkmcnt(0)
    s_load_dword s53, s[24:25], 0
    s_mov_b32 s32, s10
    s_mov_b32 s33, s11
    s_mov_b32 s34, 0x400000
    s_mov_b32 s35, 0x20000
    buffer_load_dwordx4 v[40:43], v1, s[32:35], s46 offen nt
    s_add_u32 s46, s46, 8192
    buffer_load_dwordx4 v[44:47], v1, s[32:35], s46 offen nt
    s_add_u32 s46, s46, 8192
    buffer_load_dwordx4 v[48:51], v1, s[32:35], s46 offen nt
    s_add_u32 s46, s46, 8192
    buffer_load_dwordx4 v[52:55], v1, s[32:35], s46 offen nt
    s_add_u32 s46, s46, 8192
    buffer_load_dwordx4 v[56:59], v1, s[32:35], s46 offen nt
    s_add_u32 s46, s46, 8192
    buffer_load_dwordx4 v[60:63], v1, s[32:35], s46 offen nt
    s_add_u32 s46, s46, 8192
    buffer_load_dwordx4 v[64:67], v1, s[32:35], s46 offen nt
    s_add_u32 s46, s46, 8192
    buffer_load_dwordx4 v[68:71], v1, s[32:35], s46 offen nt
    s_add_u32 s46, s46, 466944
    buffer_load_dwordx4 v[72:75], v1, s[32:35], s46 offen nt
    s_add_u32 s46, s46, 8192
    buffer_load_dwordx4 v[76:79], v1, s[32:35], s46 offen nt
    s_add_u32 s46, s46, 8192
    buffer_load_dwordx4 v[80:83], v1, s[32:35], s46 offen nt
    s_add_u32 s46, s46, 8192
    buffer_load_dwordx4 v[84:87], v1, s[32:35], s46 offen nt
    s_add_u32 s46, s46, 8192
    buffer_load_dwordx4 v[88:91], v1, s[32:35], s46 offen nt
    s_add_u32 s46, s46, 8192
    buffer_load_dwordx4 v[92:95], v1, s[32:35], s46 offen nt
    s_add_u32 s46, s46, 8192
    buffer_load_dwordx4 v[96:99], v1, s[32:35], s46 offen nt
    s_add_u32 s46, s46, 8192
    buffer_load_dwordx4 v[100:103], v1, s[32:35], s46 offen nt
    s_barrier
    s_branch L_H0c
L_H1a:
    s_mov_b32 s44, 28672
    v_mul_lo_u32 v1, v4, s44
    v_lshl_add_u32 v1, v5, 4, v1
    s_cmp_eq_u32 s27, 0
    s_cselect_b64 vcc, -1, 0
    v_mov_b32 v4, 0x40000000
    v_cndmask_b32 v1, v1, v4, vcc
    s_sub_u32 s44, s27, 1
    s_and_b32 s44, s44, 7
    s_lshl_b32 s44, s44, 2
    s_add_u32 s44, s44, s29
    s_lshl_b32 s47, s44, 7
    s_lshl_b32 s45, s30, 7
    s_mul_i32 s46, s30, 229376
    s_add_u32 s46, s46, s47
    s_waitcnt lgkmcnt(0)
    s_load_dword s53, s[24:25], 0
    s_mov_b32 s32, s16
    s_mov_b32 s33, s17
    s_mov_b32 s34, 0x1c0000
    s_mov_b32 s35, 0x20000
    buffer_load_dwordx4 v[40:43], v1, s[32:35], s46 offen nt
    s_add_u32 s46, s46, 3584
    buffer_load_dwordx4 v[44:47], v1, s[32:35], s46 offen nt
    s_add_u32 s46, s46, 3584
    buffer_load_dwordx4 v[48:51], v1, s[32:35], s46 offen nt
    s_add_u32 s46, s46, 3584
    buffer_load_dwordx4 v[52:55], v1, s[32:35], s46 offen nt
    s_add_u32 s46, s46, 3584
    buffer_load_dwordx4 v[56:59], v1, s[32:35], s46 offen nt
    s_add_u32 s46, s46, 3584
    buffer_load_dwordx4 v[60:63], v1, s[32:35], s46 offen nt
    s_add_u32 s46, s46, 3584
    buffer_load_dwordx4 v[64:67], v1, s[32:35], s46 offen nt
    s_add_u32 s46, s46, 3584
    buffer_load_dwordx4 v[68:71], v1, s[32:35], s46 offen nt
    s_barrier
    s_branch L_H1c
L_H23:
    s_waitcnt lgkmcnt(0)
    s_load_dword s53, s[24:25], 0
    s_cmp_eq_u32 s26, 3
    s_cbranch_scc1 L_H3a
    s_mov_b32 s40, s24
    s_mov_b32 s41, s25
    s_mov_b32 s42, 0x400000
    s_mov_b32 s43, 0x20000
    v_mov_b32 v24, -1
    v_mov_b32 v25, -1
    v_mov_b32 v26, -1
    v_mov_b32 v27, -1
    v_lshlrev_b32 v1, 4, v0
    s_lshl_b32 s45, s27, 5
    s_add_u32 s45, s45, s28
    s_lshl_b32 s46, s45, 10
    s_add_u32 s46, s46, 1310720
    s_cmp_ge_u32 s28, (L_exit - L_H3c) / 1024
    s_cbranch_scc1 L_nowarm
    s_getpc_b64 s[44:45]
L_pc:
    s_add_u32 s44, s44, L_exit - L_pc - 1024
    s_addc_u32 s45, s45, 0
    s_lshl_b32 s46, s28, 10
    s_sub_u32 s44, s44, s46
    s_subb_u32 s45, s45, 0
    v_lshlrev_b32 v1, 4, v0
    global_load_dwordx4 v[8:11], v1, s[44:45]
L_nowarm:
    ds_write_b128 v1, v[24:27] offset:12544
    ds_write_b128 v1, v[24:27] offset:13568
    ds_write_b128 v1, v[24:27] offset:14592
    ds_write_b128 v1, v[24:27] offset:15616
    s_barrier
    s_branch L_H23b
L_H3a:
    v_lshlrev_b32 v160, 10, v2
    v_lshl_add_u32 v160, v3, 4, v160
    s_mov_b32 s36, s4
    s_mov_b32 s37, s5
    s_mov_b32 s38, 0x1000
    s_mov_b32 s39, 0x20000
    buffer_load_dwordx4 v[40:43], v160, s[36:39], 0 offen offset:0
    buffer_load_dwordx4 v[44:47], v160, s[36:39], 0 offen offset:256
    buffer_load_dwordx4 v[48:51], v160, s[36:39], 0 offen offset:512
    buffer_load_dwordx4 v[52:55], v160, s[36:39], 0 offen offset:768
    s_barrier
    s_branch L_H3c
L_K1:
    s_barrier
    buffer_load_dwordx4 v[60:63], v1, s[32:35], s62 offen offset:3072 nt
    s_movk_i32 s62, 16384
    buffer_load_dwordx4 v[48:51], v1, s[32:35], s62 offen offset:0 nt
    s_nop 0
    buffer_load_dwordx4 v[64:67], v1, s[32:35], s62 offen offset:1024 nt
    s_nop 0
    buffer_load_dwordx4 v[52:55], v1, s[32:35], s62 offen offset:2048 nt
    s_nop 0
    buffer_load_dwordx4 v[68:71], v1, s[32:35], s62 offen offset:3072 nt
    s_mov_b32 s62, 32768
    buffer_load_dwordx4 v[72:75], v1, s[32:35], s62 offen offset:0 nt
    s_nop 0
    buffer_load_dwordx4 v[88:91], v1, s[32:35], s62 offen offset:1024 nt
    s_nop 0
    buffer_load_dwordx4 v[76:79], v1, s[32:35], s62 offen offset:2048 nt
    s_nop 0
    buffer_load_dwordx4 v[92:95], v1, s[32:35], s62 offen offset:3072 nt
    s_mov_b32 s62, 49152
    buffer_load_dwordx4 v[80:83], v1, s[32:35], s62 offen offset:0 nt
    s_nop 0
    buffer_load_dwordx4 v[96:99], v1, s[32:35], s62 offen offset:1024 nt
    s_nop 0
    buffer_load_dwordx4 v[84:87], v1, s[32:35], s62 offen offset:2048 nt
    s_nop 0
    buffer_load_dwordx4 v[100:103], v1, s[32:35], s62 offen offset:3072 nt
    s_mov_b32 s62, 65536
    buffer_load_dwordx4 v[104:107], v1, s[32:35], s62 offen offset:0 nt
    s_nop 0
    buffer_load_dwordx4 v[120:123], v1, s[32:35], s62 offen offset:1024 nt
    s_nop 0
    buffer_load_dwordx4 v[108:111], v1, s[32:35], s62 offen offset:2048 nt
    s_nop 0
    buffer_load_dwordx4 v[124:127], v1, s[32:35], s62 offen offset:3072 nt
    s_mov_b32 s62, 81920
    buffer_load_dwordx4 v[112:115], v1, s[32:35], s62 offen offset:0 nt
    s_nop 0
    buffer_load_dwordx4 v[128:131], v1, s[32:35], s62 offen offset:1024 nt
    s_nop 0
    buffer_load_dwordx4 v[116:119], v1, s[32:35], s62 offen offset:2048 nt
    s_nop 0
    buffer_load_dwordx4 v[132:135], v1, s[32:35], s62 offen offset:3072 nt
    s_mov_b32 s62, 98304
    buffer_load_dwordx4 v[136:139], v1, s[32:35], s62 offen offset:0 nt
    s_nop 0
    buffer_load_dwordx4 v[152:155], v1, s[32:35], s62 offen offset:1024 nt
    s_nop 0
    buffer_load_dwordx4 v[140:143], v1, s[32:35], s62 offen offset:2048 nt
    s_nop 0
    buffer_load_dwordx4 v[156:159], v1, s[32:35], s62 offen offset:3072 nt
    s_mov_b32 s62, 114688
    buffer_load_dwordx4 v[144:147], v1, s[32:35], s62 offen offset:0 nt
    s_nop 0
    buffer_load_dwordx4 v[160:163], v1, s[32:35], s62 offen offset:1024 nt
    s_nop 0
    buffer_load_dwordx4 v[148:151], v1, s[32:35], s62 offen offset:2048 nt
    s_nop 0
    buffer_load_dwordx4 v[164:167], v1, s[32:35], s62 offen offset:3072 nt
    s_mov_b64 exec, 1
    ds_add_u32 v6, v7 offset:60
    s_mov_b64 exec, -1
    s_branch L_K2
L_H3c:
    s_mov_b32 s40, s24
    s_mov_b32 s41, s25
    s_mov_b32 s42, 0x400000
    s_mov_b32 s43, 0x20000
    s_waitcnt vmcnt(0)
    v_lshlrev_b32 v120, 16, v40
    v_and_b32 v121, 0xffff0000, v40
    v_lshlrev_b32 v122, 16, v41
    v_and_b32 v123, 0xffff0000, v41
    v_lshlrev_b32 v124, 16, v42
    v_and_b32 v125, 0xffff0000, v42
    v_lshlrev_b32 v126, 16, v43
    v_and_b32 v127, 0xffff0000, v43
    v_lshlrev_b32 v128, 16, v44
    v_and_b32 v129, 0xffff0000, v44
    v_lshlrev_b32 v130, 16, v45
    v_and_b32 v131, 0xffff0000, v45
    v_lshlrev_b32 v132, 16, v46
    v_and_b32 v133, 0xffff0000, v46
    v_lshlrev_b32 v134, 16, v47
    v_and_b32 v135, 0xffff0000, v47
    v_lshlrev_b32 v136, 16, v48
    v_and_b32 v137, 0xffff0000, v48
    v_lshlrev_b32 v138, 16, v49
    v_and_b32 v139, 0xffff0000, v49
    v_lshlrev_b32 v140, 16, v50
    v_and_b32 v141, 0xffff0000, v50
    v_lshlrev_b32 v142, 16, v51
    v_and_b32 v143, 0xffff0000, v51
    v_lshlrev_b32 v144, 16, v52
    v_and_b32 v145, 0xffff0000, v52
    v_lshlrev_b32 v146, 16, v53
    v_and_b32 v147, 0xffff0000, v53
    v_lshlrev_b32 v148, 16, v54
    v_and_b32 v149, 0xffff0000, v54
    v_lshlrev_b32 v150, 16, v55
    v_and_b32 v151, 0xffff0000, v55
    v_pk_add_f32 v[104:105], v[120:121], v[122:123]
    v_pk_add_f32 v[106:107], v[124:125], v[126:127]
    v_pk_add_f32 v[108:109], v[128:129], v[130:131]
    v_pk_add_f32 v[110:111], v[132:133], v[134:135]
    v_pk_add_f32 v[112:113], v[136:137], v[138:139]
    v_pk_add_f32 v[114:115], v[140:141], v[142:143]
    v_pk_add_f32 v[116:117], v[144:145], v[146:147]
    v_pk_add_f32 v[118:119], v[148:149], v[150:151]
    v_pk_add_f32 v[104:105], v[104:105], v[112:113]
    v_pk_add_f32 v[106:107], v[106:107], v[114:115]
    v_pk_add_f32 v[108:109], v[108:109], v[116:117]
    v_pk_add_f32 v[110:111], v[110:111], v[118:119]
    v_pk_add_f32 v[104:105], v[104:105], v[108:109]
    v_pk_add_f32 v[106:107], v[106:107], v[110:111]
    v_pk_add_f32 v[104:105], v[104:105], v[106:107]
    v_add_f32 v162, v104, v105
    s_nop 1
    v_add_f32_dpp v162, v162, v162 row_ror:8 row_mask:0xf bank_mask:0xf
    s_nop 1
    v_add_f32_dpp v162, v162, v162 row_ror:4 row_mask:0xf bank_mask:0xf
    s_nop 1
    v_add_f32_dpp v162, v162, v162 row_ror:2 row_mask:0xf bank_mask:0xf
    s_nop 1
    v_add_f32_dpp v162, v162, v162 row_ror:1 row_mask:0xf bank_mask:0xf
    v_mul_f32 v162, 0xbb000000, v162
    v_mov_b32 v163, v162
    v_pk_add_f32 v[120:121], v[120:121], v[162:163]
    v_pk_add_f32 v[122:123], v[122:123], v[162:163]
    v_pk_add_f32 v[124:125], v[124:125], v[162:163]
    v_pk_add_f32 v[126:127], v[126:127], v[162:163]
    v_pk_add_f32 v[128:129], v[128:129], v[162:163]
    v_pk_add_f32 v[130:131], v[130:131], v[162:163]
    v_pk_add_f32 v[132:133], v[132:133], v[162:163]
    v_pk_add_f32 v[134:135], v[134:135], v[162:163]
    v_pk_add_f32 v[136:137], v[136:137], v[162:163]
    v_pk_add_f32 v[138:139], v[138:139], v[162:163]
    v_pk_add_f32 v[140:141], v[140:141], v[162:163]
    v_pk_add_f32 v[142:143], v[142:143], v[162:163]
    v_pk_add_f32 v[144:145], v[144:145], v[162:163]
    v_pk_add_f32 v[146:147], v[146:147], v[162:163]
    v_pk_add_f32 v[148:149], v[148:149], v[162:163]
    v_pk_add_f32 v[150:151], v[150:151], v[162:163]
    v_pk_mul_f32 v[104:105], v[120:121], v[120:121]
    v_pk_mul_f32 v[106:107], v[122:123], v[122:123]
    v_pk_mul_f32 v[108:109], v[124:125], v[124:125]
    v_pk_mul_f32 v[110:111], v[126:127], v[126:127]
    v_pk_fma_f32 v[104:105], v[128:129], v[128:129], v[104:105]
    v_pk_fma_f32 v[106:107], v[130:131], v[130:131], v[106:107]
    v_pk_fma_f32 v[108:109], v[132:133], v[132:133], v[108:109]
    v_pk_fma_f32 v[110:111], v[134:135], v[134:135], v[110:111]
    v_pk_fma_f32 v[104:105], v[136:137], v[136:137], v[104:105]
    v_pk_fma_f32 v[106:107], v[138:139], v[138:139], v[106:107]
    v_pk_fma_f32 v[108:109], v[140:141], v[140:141], v[108:109]
    v_pk_fma_f32 v[110:111], v[142:143], v[142:143], v[110:111]
    v_pk_fma_f32 v[104:105], v[144:145], v[144:145], v[104:105]
    v_pk_fma_f32 v[106:107], v[146:147], v[146:147], v[106:107]
    v_pk_fma_f32 v[108:109], v[148:149], v[148:149], v[108:109]
    v_pk_fma_f32 v[110:111], v[150:151], v[150:151], v[110:111]
    v_pk_add_f32 v[104:105], v[104:105], v[108:109]
    v_pk_add_f32 v[106:107], v[106:107], v[110:111]
    v_pk_add_f32 v[104:105], v[104:105], v[106:107]
    v_add_f32 v164, v104, v105
    s_nop 1
    v_add_f32_dpp v164, v164, v164 row_ror:8 row_mask:0xf bank_mask:0xf
    s_nop 1
    v_add_f32_dpp v164, v164, v164 row_ror:4 row_mask:0xf bank_mask:0xf
    s_nop 1
    v_add_f32_dpp v164, v164, v164 row_ror:2 row_mask:0xf bank_mask:0xf
    s_nop 1
    v_add_f32_dpp v164, v164, v164 row_ror:1 row_mask:0xf bank_mask:0xf
    v_mul_f32 v164, 0x3b000000, v164
    v_cvt_pk_bf16_f32 v164, v164, v164
    v_and_b32 v164, 0xffff0000, v164
    v_add_f32 v164, 0x3727c5ac, v164
    v_cvt_pk_bf16_f32 v164, v164, v164
    v_and_b32 v164, 0xffff0000, v164
    v_sqrt_f32 v164, v164
    s_nop 0
    v_cvt_pk_bf16_f32 v164, v164, v164
    v_and_b32 v164, 0xffff0000, v164
    v_rcp_f32 v164, v164
    v_cvt_pk_bf16_f32 v162, v162, v162
    v_and_b32 v162, 0xffff0000, v162
    v_mov_b32 v163, v162
    v_mov_b32 v165, v164
    v_lshlrev_b32 v120, 16, v40
    v_and_b32 v121, 0xffff0000, v40
    v_lshlrev_b32 v122, 16, v41
    v_and_b32 v123, 0xffff0000, v41
    v_lshlrev_b32 v124, 16, v42
    v_and_b32 v125, 0xffff0000, v42
    v_lshlrev_b32 v126, 16, v43
    v_and_b32 v127, 0xffff0000, v43
    v_pk_add_f32 v[120:121], v[120:121], v[162:163]
    v_pk_add_f32 v[122:123], v[122:123], v[162:163]
    v_pk_add_f32 v[124:125], v[124:125], v[162:163]
    v_pk_add_f32 v[126:127], v[126:127], v[162:163]
    v_cvt_pk_bf16_f32 v40, v120, v121
    v_cvt_pk_bf16_f32 v41, v122, v123
    v_cvt_pk_bf16_f32 v42, v124, v125
    v_cvt_pk_bf16_f32 v43, v126, v127
    v_lshlrev_b32 v120, 16, v40
    v_and_b32 v121, 0xffff0000, v40
    v_lshlrev_b32 v122, 16, v41
    v_and_b32 v123, 0xffff0000, v41
    v_lshlrev_b32 v124, 16, v42
    v_and_b32 v125, 0xffff0000, v42
    v_lshlrev_b32 v126, 16, v43
    v_and_b32 v127, 0xffff0000, v43
    v_pk_mul_f32 v[120:121], v[120:121], v[164:165]
    v_pk_mul_f32 v[122:123], v[122:123], v[164:165]
    v_pk_mul_f32 v[124:125], v[124:125], v[164:165]
    v_pk_mul_f32 v[126:127], v[126:127], v[164:165]
    v_cvt_pk_bf16_f32 v40, v120, v121
    v_cvt_pk_bf16_f32 v41, v122, v123
    v_cvt_pk_bf16_f32 v42, v124, v125
    v_cvt_pk_bf16_f32 v43, v126, v127
    ds_write_b128 v160, v[40:43] offset:1536
    v_lshlrev_b32 v120, 16, v44
    v_and_b32 v121, 0xffff0000, v44
    v_lshlrev_b32 v122, 16, v45
    v_and_b32 v123, 0xffff0000, v45
    v_lshlrev_b32 v124, 16, v46
    v_and_b32 v125, 0xffff0000, v46
    v_lshlrev_b32 v126, 16, v47
    v_and_b32 v127, 0xffff0000, v47
    v_pk_add_f32 v[120:121], v[120:121], v[162:163]
    v_pk_add_f32 v[122:123], v[122:123], v[162:163]
    v_pk_add_f32 v[124:125], v[124:125], v[162:163]
    v_pk_add_f32 v[126:127], v[126:127], v[162:163]
    v_cvt_pk_bf16_f32 v44, v120, v121
    v_cvt_pk_bf16_f32 v45, v122, v123
    v_cvt_pk_bf16_f32 v46, v124, v125
    v_cvt_pk_bf16_f32 v47, v126, v127
    v_lshlrev_b32 v120, 16, v44
    v_and_b32 v121, 0xffff0000, v44
    v_lshlrev_b32 v122, 16, v45
    v_and_b32 v123, 0xffff0000, v45
    v_lshlrev_b32 v124, 16, v46
    v_and_b32 v125, 0xffff0000, v46
    v_lshlrev_b32 v126, 16, v47
    v_and_b32 v127, 0xffff0000, v47
    v_pk_mul_f32 v[120:121], v[120:121], v[164:165]
    v_pk_mul_f32 v[122:123], v[122:123], v[164:165]
    v_pk_mul_f32 v[124:125], v[124:125], v[164:165]
    v_pk_mul_f32 v[126:127], v[126:127], v[164:165]
    v_cvt_pk_bf16_f32 v44, v120, v121
    v_cvt_pk_bf16_f32 v45, v122, v123
    v_cvt_pk_bf16_f32 v46, v124, v125
    v_cvt_pk_bf16_f32 v47, v126, v127
    ds_write_b128 v160, v[44:47] offset:1792
    v_lshlrev_b32 v120, 16, v48
    v_and_b32 v121, 0xffff0000, v48
    v_lshlrev_b32 v122, 16, v49
    v_and_b32 v123, 0xffff0000, v49
    v_lshlrev_b32 v124, 16, v50
    v_and_b32 v125, 0xffff0000, v50
    v_lshlrev_b32 v126, 16, v51
    v_and_b32 v127, 0xffff0000, v51
    v_pk_add_f32 v[120:121], v[120:121], v[162:163]
    v_pk_add_f32 v[122:123], v[122:123], v[162:163]
    v_pk_add_f32 v[124:125], v[124:125], v[162:163]
    v_pk_add_f32 v[126:127], v[126:127], v[162:163]
    v_cvt_pk_bf16_f32 v48, v120, v121
    v_cvt_pk_bf16_f32 v49, v122, v123
    v_cvt_pk_bf16_f32 v50, v124, v125
    v_cvt_pk_bf16_f32 v51, v126, v127
    v_lshlrev_b32 v120, 16, v48
    v_and_b32 v121, 0xffff0000, v48
    v_lshlrev_b32 v122, 16, v49
    v_and_b32 v123, 0xffff0000, v49
    v_lshlrev_b32 v124, 16, v50
    v_and_b32 v125, 0xffff0000, v50
    v_lshlrev_b32 v126, 16, v51
    v_and_b32 v127, 0xffff0000, v51
    v_pk_mul_f32 v[120:121], v[120:121], v[164:165]
    v_pk_mul_f32 v[122:123], v[122:123], v[164:165]
    v_pk_mul_f32 v[124:125], v[124:125], v[164:165]
    v_pk_mul_f32 v[126:127], v[126:127], v[164:165]
    v_cvt_pk_bf16_f32 v48, v120, v121
    v_cvt_pk_bf16_f32 v49, v122, v123
    v_cvt_pk_bf16_f32 v50, v124, v125
    v_cvt_pk_bf16_f32 v51, v126, v127
    ds_write_b128 v160, v[48:51] offset:2048
    v_lshlrev_b32 v120, 16, v52
    v_and_b32 v121, 0xffff0000, v52
    v_lshlrev_b32 v122, 16, v53
    v_and_b32 v123, 0xffff0000, v53
    v_lshlrev_b32 v124, 16, v54
    v_and_b32 v125, 0xffff0000, v54
    v_lshlrev_b32 v126, 16, v55
    v_and_b32 v127, 0xffff0000, v55
    v_pk_add_f32 v[120:121], v[120:121], v[162:163]
    v_pk_add_f32 v[122:123], v[122:123], v[162:163]
    v_pk_add_f32 v[124:125], v[124:125], v[162:163]
    v_pk_add_f32 v[126:127], v[126:127], v[162:163]
    v_cvt_pk_bf16_f32 v52, v120, v121
    v_cvt_pk_bf16_f32 v53, v122, v123
    v_cvt_pk_bf16_f32 v54, v124, v125
    v_cvt_pk_bf16_f32 v55, v126, v127
    v_lshlrev_b32 v120, 16, v52
    v_and_b32 v121, 0xffff0000, v52
    v_lshlrev_b32 v122, 16, v53
    v_and_b32 v123, 0xffff0000, v53
    v_lshlrev_b32 v124, 16, v54
    v_and_b32 v125, 0xffff0000, v54
    v_lshlrev_b32 v126, 16, v55
    v_and_b32 v127, 0xffff0000, v55
    v_pk_mul_f32 v[120:121], v[120:121], v[164:165]
    v_pk_mul_f32 v[122:123], v[122:123], v[164:165]
    v_pk_mul_f32 v[124:125], v[124:125], v[164:165]
    v_pk_mul_f32 v[126:127], v[126:127], v[164:165]
    v_cvt_pk_bf16_f32 v52, v120, v121
    v_cvt_pk_bf16_f32 v53, v122, v123
    v_cvt_pk_bf16_f32 v54, v124, v125
    v_cvt_pk_bf16_f32 v55, v126, v127
    ds_write_b128 v160, v[52:55] offset:2304
    s_mov_b64 exec, 1
    ds_add_u32 v6, v7 offset:68
    s_mov_b64 exec, -1
L_H23b:
    v_mov_b32 v166, 0
    s_mov_b32 s51, 0x05040100
    s_mov_b32 s52, 0x07060302
    s_mov_b32 s54, 0xf000f
    s_mov_b32 s55, 0xf000f
    s_mov_b32 s56, 0xf000f0
    s_mov_b32 s57, 0xf000f0
    s_mov_b32 s58, 0xf000f00
    s_mov_b32 s59, 0xf000f00
    s_mov_b32 s60, 0xf000f000
    s_mov_b32 s61, 0xf000f000
    s_lshr_b32 s44, s28, 2
    s_lshl_b32 s70, s27, 3
    s_add_u32 s70, s70, s44
    s_and_b32 s71, s28, 3
    s_getreg_b32 s73, hwreg(HW_REG_XCC_ID, 0, 4)
    s_waitcnt lgkmcnt(0)
    s_mul_i32 s53, s53, 0x9e3779b1
    s_add_u32 s53, s53, 0x7f4a7c15
    s_bfe_u32 s96, s53, 0x80000
    s_bfe_u32 s97, s53, 0x80008
    s_bfe_u32 s98, s53, 0x80010
    s_bfe_u32 s99, s53, 0x80018
    s_mov_b32 s78, 0xffffff00
    s_branch L_qwait
L_H0c:
    v_mov_b32 v166, 0
    s_mov_b32 s51, 0x05040100
    s_mov_b32 s52, 0x07060302
    s_mov_b32 s54, 0xf000f
    s_mov_b32 s55, 0xf000f
    s_mov_b32 s56, 0xf000f0
    s_mov_b32 s57, 0xf000f0
    s_mov_b32 s58, 0xf000f00
    s_mov_b32 s59, 0xf000f00
    s_mov_b32 s60, 0xf000f000
    s_mov_b32 s61, 0xf000f000
    s_lshr_b32 s44, s28, 2
    s_lshl_b32 s70, s27, 3
    s_add_u32 s70, s70, s44
    s_and_b32 s71, s28, 3
    s_getreg_b32 s73, hwreg(HW_REG_XCC_ID, 0, 4)
    s_mov_b32 s40, s24
    s_mov_b32 s41, s25
    s_mov_b32 s42, 0x400000
    s_mov_b32 s43, 0x20000
    v_and_b32 v4, 3, v0
    v_lshlrev_b32 v4, 10, v4
    v_lshl_add_u32 v4, v2, 5, v4
    v_bfe_u32 v5, v0, 2, 1
    v_lshl_add_u32 v4, v5, 4, v4
    s_add_u32 s44, s45, 1536
    v_add_u32 v4, s44, v4
    v_mov_b32 v5, 128
    s_mov_b32 vcc_lo, 0x00ff00ff
    s_mov_b32 vcc_hi, 0x00ff00ff
    v_cndmask_b32 v160, v5, v4, vcc
    v_cndmask_b32 v161, v4, v5, vcc
    s_waitcnt lgkmcnt(0)
    s_mul_i32 s53, s53, 0x9e3779b1
    s_add_u32 s53, s53, 0x7f4a7c15
    s_bfe_u32 s96, s53, 0x80000
    s_bfe_u32 s97, s53, 0x80008
    s_bfe_u32 s98, s53, 0x80010
    s_bfe_u32 s99, s53, 0x80018
    s_mov_b32 s78, 0xffffff00
    v_lshrrev_b32 v4, 5, v0
    v_and_b32 v5, 31, v0
    v_lshlrev_b32 v166, 14, v4
    v_lshl_add_u32 v166, v5, 4, v166
    v_mul_u32_u24 v165, 12, v5
    v_lshl_add_u32 v165, v4, 8, v165
    v_cmp_eq_u32 s[62:63], 21, v5
    s_lshl_b32 s48, s27, 16
    s_lshr_b32 s47, s30, 1
    s_lshl_b32 s47, s47, 12
    s_add_u32 s48, s48, s47
    s_lshl_b32 s47, s29, 10
    s_add_u32 s48, s48, s47
    s_and_b32 s47, s30, 1
    s_lshl_b32 s47, s47, 9
    s_add_u32 s48, s48, s47
    s_add_u32 s48, s48, 4096
    s_add_u32 s49, s48, 32768
    v_mov_b32 v123, s53
    v_mov_b32 v127, s53
    v_mov_b32 v128, s73
    v_add_u32 v167, 5632, v165
L_w15:
    ds_read_b32 v5, v6 offset:68
    s_waitcnt lgkmcnt(0)
    v_readfirstlane_b32 s44, v5
    s_nop 0
    s_cmp_ge_u32 s44, 1
    s_cbranch_scc1 L_d16
    s_sleep 1
    s_sub_u32 s50, s50, 1
    s_cbranch_scc0 L_w15
    s_endpgm
L_d16:
    ds_read_b128 v[136:139], v160 offset:0
    ds_read_b128 v[140:143], v161 offset:0
    ds_read_b128 v[144:147], v160 offset:128
    ds_read_b128 v[148:151], v161 offset:128
    s_waitcnt vmcnt(8) lgkmcnt(0)
    v_perm_b32 v16, v44, v40, s51
    v_perm_b32 v17, v52, v48, s51
    v_perm_b32 v18, v60, v56, s51
    v_perm_b32 v19, v68, v64, s51
    v_perm_b32 v20, v44, v40, s52
    v_perm_b32 v21, v52, v48, s52
    v_perm_b32 v22, v60, v56, s52
    v_perm_b32 v23, v68, v64, s52
    v_mfma_f32_16x16x32_bf16 v[24:27], v[136:139], v[16:19], 0
    v_perm_b32 v16, v45, v41, s51
    v_perm_b32 v17, v53, v49, s51
    v_perm_b32 v18, v61, v57, s51
    v_perm_b32 v19, v69, v65, s51
    v_mfma_f32_16x16x32_bf16 v[24:27], v[140:143], v[20:23], v[24:27]
    v_perm_b32 v20, v45, v41, s52
    v_perm_b32 v21, v53, v49, s52
    v_perm_b32 v22, v61, v57, s52
    v_perm_b32 v23, v69, v65, s52
    v_mfma_f32_16x16x32_bf16 v[28:31], v[136:139], v[16:19], 0
    v_perm_b32 v16, v46, v42, s51
    v_perm_b32 v17, v54, v50, s51
    v_perm_b32 v18, v62, v58, s51
    v_perm_b32 v19, v70, v66, s51
    v_mfma_f32_16x16x32_bf16 v[28:31], v[140:143], v[20:23], v[28:31]
    v_perm_b32 v20, v46, v42, s52
    v_perm_b32 v21, v54, v50, s52
    v_perm_b32 v22, v62, v58, s52
    v_perm_b32 v23, v70, v66, s52
    v_mfma_f32_16x16x32_bf16 v[32:35], v[136:139], v[16:19], 0
    v_perm_b32 v16, v47, v43, s51
    v_perm_b32 v17, v55, v51, s51
    v_perm_b32 v18, v63, v59, s51
    v_perm_b32 v19, v71, v67, s51
    v_mfma_f32_16x16x32_bf16 v[32:35], v[140:143], v[20:23], v[32:35]
    v_perm_b32 v20, v47, v43, s52
    v_perm_b32 v21, v55, v51, s52
    v_perm_b32 v22, v63, v59, s52
    v_perm_b32 v23, v71, v67, s52
    v_mfma_f32_16x16x32_bf16 v[36:39], v[136:139], v[16:19], 0
    s_nop 0
    v_mfma_f32_16x16x32_bf16 v[36:39], v[140:143], v[20:23], v[36:39]
    s_waitcnt vmcnt(0)
    v_perm_b32 v16, v76, v72, s51
    v_perm_b32 v17, v84, v80, s51
    v_perm_b32 v18, v92, v88, s51
    v_perm_b32 v19, v100, v96, s51
    v_perm_b32 v20, v76, v72, s52
    v_perm_b32 v21, v84, v80, s52
    v_perm_b32 v22, v92, v88, s52
    v_perm_b32 v23, v100, v96, s52
    v_mfma_f32_16x16x32_bf16 v[24:27], v[144:147], v[16:19], v[24:27]
    v_perm_b32 v16, v77, v73, s51
    v_perm_b32 v17, v85, v81, s51
    v_perm_b32 v18, v93, v89, s51
    v_perm_b32 v19, v101, v97, s51
    v_mfma_f32_16x16x32_bf16 v[24:27], v[148:151], v[20:23], v[24:27]
    v_perm_b32 v20, v77, v73, s52
    v_perm_b32 v21, v85, v81, s52
    v_perm_b32 v22, v93, v89, s52
    v_perm_b32 v23, v101, v97, s52
    v_mfma_f32_16x16x32_bf16 v[28:31], v[144:147], v[16:19], v[28:31]
    v_perm_b32 v16, v78, v74, s51
    v_perm_b32 v17, v86, v82, s51
    v_perm_b32 v18, v94, v90, s51
    v_perm_b32 v19, v102, v98, s51
    v_mfma_f32_16x16x32_bf16 v[28:31], v[148:151], v[20:23], v[28:31]
    v_perm_b32 v20, v78, v74, s52
    v_perm_b32 v21, v86, v82, s52
    v_perm_b32 v22, v94, v90, s52
    v_perm_b32 v23, v102, v98, s52
    v_mfma_f32_16x16x32_bf16 v[32:35], v[144:147], v[16:19], v[32:35]
    v_perm_b32 v16, v79, v75, s51
    v_perm_b32 v17, v87, v83, s51
    v_perm_b32 v18, v95, v91, s51
    v_perm_b32 v19, v103, v99, s51
    v_mfma_f32_16x16x32_bf16 v[32:35], v[148:151], v[20:23], v[32:35]
    v_perm_b32 v20, v79, v75, s52
    v_perm_b32 v21, v87, v83, s52
    v_perm_b32 v22, v95, v91, s52
    v_perm_b32 v23, v103, v99, s52
    v_mfma_f32_16x16x32_bf16 v[36:39], v[144:147], v[16:19], v[36:39]
    s_nop 0
    v_mfma_f32_16x16x32_bf16 v[36:39], v[148:151], v[20:23], v[36:39]
    v_mov_b32_dpp v24, v25 row_ror:8 row_mask:0x5 bank_mask:0xc
    v_mov_b32_dpp v26, v27 row_ror:8 row_mask:0x5 bank_mask:0xc
    v_mov_b32_dpp v28, v29 row_ror:8 row_mask:0x5 bank_mask:0xc
    v_mov_b32_dpp v30, v31 row_ror:8 row_mask:0x5 bank_mask:0xc
    v_mov_b32_dpp v32, v33 row_ror:8 row_mask:0x5 bank_mask:0xc
    v_mov_b32_dpp v34, v35 row_ror:8 row_mask:0x5 bank_mask:0xc
    s_nop 1
    v_mov_b32_dpp v36, v37 row_ror:8 row_mask:0x5 bank_mask:0xc
    v_mov_b32_dpp v38, v39 row_ror:8 row_mask:0x5 bank_mask:0xc
    v_mov_b32_dpp v24, v24 row_ror:8 row_mask:0xa bank_mask:0x3
    v_mov_b32_dpp v26, v26 row_ror:8 row_mask:0xa bank_mask:0x3
    v_mov_b32_dpp v28, v28 row_ror:8 row_mask:0xa bank_mask:0x3
    v_mov_b32_dpp v30, v30 row_ror:8 row_mask:0xa bank_mask:0x3
    v_mov_b32_dpp v32, v32 row_ror:8 row_mask:0xa bank_mask:0x3
    v_mov_b32_dpp v34, v34 row_ror:8 row_mask:0xa bank_mask:0x3
    v_mov_b32_dpp v36, v36 row_ror:8 row_mask:0xa bank_mask:0x3
    v_mov_b32_dpp v38, v38 row_ror:8 row_mask:0xa bank_mask:0x3
    v_mov_b32_dpp v24, v25 quad_perm:[0,1,2,3] row_mask:0xa bank_mask:0xc
    v_mov_b32_dpp v26, v27 quad_perm:[0,1,2,3] row_mask:0xa bank_mask:0xc
    v_mov_b32_dpp v28, v29 quad_perm:[0,1,2,3] row_mask:0xa bank_mask:0xc
    v_mov_b32_dpp v30, v31 quad_perm:[0,1,2,3] row_mask:0xa bank_mask:0xc
    v_mov_b32_dpp v32, v33 quad_perm:[0,1,2,3] row_mask:0xa bank_mask:0xc
    v_mov_b32_dpp v34, v35 quad_perm:[0,1,2,3] row_mask:0xa bank_mask:0xc
    v_mov_b32_dpp v36, v37 quad_perm:[0,1,2,3] row_mask:0xa bank_mask:0xc
    v_mov_b32_dpp v38, v39 quad_perm:[0,1,2,3] row_mask:0xa bank_mask:0xc
    v_permlane16_swap_b32 v24, v26
    v_permlane16_swap_b32 v28, v30
    v_permlane16_swap_b32 v32, v34
    v_permlane16_swap_b32 v36, v38
    v_add_f32 v24, v24, v26
    v_add_f32 v28, v28, v30
    v_add_f32 v32, v32, v34
    v_add_f32 v36, v36, v38
    v_lshlrev_b32 v4, 5, v0
    v_and_b32 v4, 0x3ff, v4
    v_lshrrev_b32 v5, 5, v0
    v_lshl_add_u32 v4, v5, 2, v4
    ds_write_b32 v4, v24 offset:5632
    ds_write_b32 v4, v28 offset:5640
    ds_write_b32 v4, v32 offset:5648
    ds_write_b32 v4, v36 offset:5656
    ds_read2_b32 v[120:121], v167 offset0:0 offset1:1
    ds_read_b32 v122, v165 offset:5640
    ds_read2_b32 v[124:125], v167 offset0:128 offset1:129
    ds_read_b32 v126, v165 offset:6152
    s_waitcnt lgkmcnt(0)
    v_cndmask_b32 v121, v121, v128, s[62:63]
    v_cndmask_b32 v125, v125, v128, s[62:63]
    s_mov_b32 exec_lo, 0x00ffffff
    s_mov_b32 exec_hi, 0x00ffffff
    buffer_store_dwordx4 v[120:123], v166, s[40:43], s48 offen
    buffer_store_dwordx4 v[124:127], v166, s[40:43], s49 offen
    s_mov_b64 exec, -1
    s_waitcnt vmcnt(0)
    s_mov_b64 exec, 1
    ds_add_u32 v6, v7 offset:0
    s_mov_b64 exec, -1
    s_branch L_qgather
L_H1c:
    v_mov_b32 v166, 0
    s_mov_b32 s51, 0x05040100
    s_mov_b32 s52, 0x07060302
    s_mov_b32 s54, 0xf000f
    s_mov_b32 s55, 0xf000f
    s_mov_b32 s56, 0xf000f0
    s_mov_b32 s57, 0xf000f0
    s_mov_b32 s58, 0xf000f00
    s_mov_b32 s59, 0xf000f00
    s_mov_b32 s60, 0xf000f000
    s_mov_b32 s61, 0xf000f000
    s_lshr_b32 s44, s28, 2
    s_lshl_b32 s70, s27, 3
    s_add_u32 s70, s70, s44
    s_and_b32 s71, s28, 3
    s_getreg_b32 s73, hwreg(HW_REG_XCC_ID, 0, 4)
    s_mov_b32 s40, s24
    s_mov_b32 s41, s25
    s_mov_b32 s42, 0x400000
    s_mov_b32 s43, 0x20000
    v_and_b32 v4, 3, v0
    v_lshlrev_b32 v4, 10, v4
    v_lshl_add_u32 v4, v2, 5, v4
    v_bfe_u32 v5, v0, 2, 1
    v_lshl_add_u32 v4, v5, 4, v4
    s_add_u32 s44, s45, 1536
    v_add_u32 v4, s44, v4
    v_mov_b32 v5, 128
    s_mov_b32 vcc_lo, 0x00ff00ff
    s_mov_b32 vcc_hi, 0x00ff00ff
    v_cndmask_b32 v160, v5, v4, vcc
    v_cndmask_b32 v161, v4, v5, vcc
    s_waitcnt lgkmcnt(0)
    s_mul_i32 s53, s53, 0x9e3779b1
    s_add_u32 s53, s53, 0x7f4a7c15
    s_bfe_u32 s96, s53, 0x80000
    s_bfe_u32 s97, s53, 0x80008
    s_bfe_u32 s98, s53, 0x80010
    s_bfe_u32 s99, s53, 0x80018
    s_mov_b32 s78, 0xffffff00
    s_lshl_b32 s62, s27, 5
    s_add_u32 s62, s62, s28
    s_lshl_b32 s62, s62, 10
    s_add_u32 s62, s62, 802816
    v_lshlrev_b32 v166, 4, v0
L_w17:
    ds_read_b32 v5, v6 offset:68
    s_waitcnt lgkmcnt(0)
    v_readfirstlane_b32 s44, v5
    s_nop 0
    s_cmp_ge_u32 s44, 1
    s_cbranch_scc1 L_d18
    s_sleep 1
    s_sub_u32 s50, s50, 1
    s_cbranch_scc0 L_w17
    s_endpgm
L_d18:
    ds_read_b128 v[136:139], v160
    ds_read_b128 v[140:143], v161
    s_waitcnt vmcnt(0) lgkmcnt(0)
    v_perm_b32 v16, v44, v40, s51
    v_perm_b32 v17, v52, v48, s51
    v_perm_b32 v18, v60, v56, s51
    v_perm_b32 v19, v68, v64, s51
    v_perm_b32 v20, v44, v40, s52
    v_perm_b32 v21, v52, v48, s52
    v_perm_b32 v22, v60, v56, s52
    v_perm_b32 v23, v68, v64, s52
    v_mfma_f32_16x16x32_bf16 v[24:27], v[136:139], v[16:19], 0
    v_perm_b32 v16, v45, v41, s51
    v_perm_b32 v17, v53, v49, s51
    v_perm_b32 v18, v61, v57, s51
    v_perm_b32 v19, v69, v65, s51
    v_mfma_f32_16x16x32_bf16 v[24:27], v[140:143], v[20:23], v[24:27]
    v_perm_b32 v20, v45, v41, s52
    v_perm_b32 v21, v53, v49, s52
    v_perm_b32 v22, v61, v57, s52
    v_perm_b32 v23, v69, v65, s52
    v_mfma_f32_16x16x32_bf16 v[28:31], v[136:139], v[16:19], 0
    v_perm_b32 v16, v46, v42, s51
    v_perm_b32 v17, v54, v50, s51
    v_perm_b32 v18, v62, v58, s51
    v_perm_b32 v19, v70, v66, s51
    v_mfma_f32_16x16x32_bf16 v[28:31], v[140:143], v[20:23], v[28:31]
    v_perm_b32 v20, v46, v42, s52
    v_perm_b32 v21, v54, v50, s52
    v_perm_b32 v22, v62, v58, s52
    v_perm_b32 v23, v70, v66, s52
    v_mfma_f32_16x16x32_bf16 v[32:35], v[136:139], v[16:19], 0
    v_perm_b32 v16, v47, v43, s51
    v_perm_b32 v17, v55, v51, s51
    v_perm_b32 v18, v63, v59, s51
    v_perm_b32 v19, v71, v67, s51
    v_mfma_f32_16x16x32_bf16 v[32:35], v[140:143], v[20:23], v[32:35]
    v_perm_b32 v20, v47, v43, s52
    v_perm_b32 v21, v55, v51, s52
    v_perm_b32 v22, v63, v59, s52
    v_perm_b32 v23, v71, v67, s52
    v_mfma_f32_16x16x32_bf16 v[36:39], v[136:139], v[16:19], 0
    s_nop 0
    v_mfma_f32_16x16x32_bf16 v[36:39], v[140:143], v[20:23], v[36:39]
    v_mov_b32_dpp v24, v25 row_ror:8 row_mask:0x5 bank_mask:0xc
    v_mov_b32_dpp v26, v27 row_ror:8 row_mask:0x5 bank_mask:0xc
    v_mov_b32_dpp v28, v29 row_ror:8 row_mask:0x5 bank_mask:0xc
    v_mov_b32_dpp v30, v31 row_ror:8 row_mask:0x5 bank_mask:0xc
    v_mov_b32_dpp v32, v33 row_ror:8 row_mask:0x5 bank_mask:0xc
    v_mov_b32_dpp v34, v35 row_ror:8 row_mask:0x5 bank_mask:0xc
    s_nop 1
    v_mov_b32_dpp v36, v37 row_ror:8 row_mask:0x5 bank_mask:0xc
    v_mov_b32_dpp v38, v39 row_ror:8 row_mask:0x5 bank_mask:0xc
    v_mov_b32_dpp v24, v24 row_ror:8 row_mask:0xa bank_mask:0x3
    v_mov_b32_dpp v26, v26 row_ror:8 row_mask:0xa bank_mask:0x3
    v_mov_b32_dpp v28, v28 row_ror:8 row_mask:0xa bank_mask:0x3
    v_mov_b32_dpp v30, v30 row_ror:8 row_mask:0xa bank_mask:0x3
    v_mov_b32_dpp v32, v32 row_ror:8 row_mask:0xa bank_mask:0x3
    v_mov_b32_dpp v34, v34 row_ror:8 row_mask:0xa bank_mask:0x3
    v_mov_b32_dpp v36, v36 row_ror:8 row_mask:0xa bank_mask:0x3
    v_mov_b32_dpp v38, v38 row_ror:8 row_mask:0xa bank_mask:0x3
    v_mov_b32_dpp v24, v25 quad_perm:[0,1,2,3] row_mask:0xa bank_mask:0xc
    v_mov_b32_dpp v26, v27 quad_perm:[0,1,2,3] row_mask:0xa bank_mask:0xc
    v_mov_b32_dpp v28, v29 quad_perm:[0,1,2,3] row_mask:0xa bank_mask:0xc
    v_mov_b32_dpp v30, v31 quad_perm:[0,1,2,3] row_mask:0xa bank_mask:0xc
    v_mov_b32_dpp v32, v33 quad_perm:[0,1,2,3] row_mask:0xa bank_mask:0xc
    v_mov_b32_dpp v34, v35 quad_perm:[0,1,2,3] row_mask:0xa bank_mask:0xc
    v_mov_b32_dpp v36, v37 quad_perm:[0,1,2,3] row_mask:0xa bank_mask:0xc
    v_mov_b32_dpp v38, v39 quad_perm:[0,1,2,3] row_mask:0xa bank_mask:0xc
    v_permlane16_swap_b32 v24, v26
    v_permlane16_swap_b32 v28, v30
    v_permlane16_swap_b32 v32, v34
    v_permlane16_swap_b32 v36, v38
    v_add_f32 v24, v24, v26
    v_add_f32 v28, v28, v30
    v_add_f32 v32, v32, v34
    v_add_f32 v36, v36, v38
    v_lshlrev_b32 v4, 5, v0
    v_and_b32 v4, 0x3ff, v4
    v_lshrrev_b32 v5, 5, v0
    v_lshl_add_u32 v4, v5, 2, v4
    ds_write_b32 v4, v24 offset:7680
    ds_write_b32 v4, v28 offset:7688
    ds_write_b32 v4, v32 offset:7696
    ds_write_b32 v4, v36 offset:7704
    ds_read_b128 v[136:139], v166 offset:7680
    s_waitcnt lgkmcnt(0)
    v_and_b32 v136, s78, v136
    v_and_b32 v137, s78, v137
    v_and_b32 v138, s78, v138
    v_and_b32 v139, s78, v139
    v_or_b32 v136, s96, v136
    v_or_b32 v137, s97, v137
    v_or_b32 v138, s98, v138
    v_or_b32 v139, s99, v139
    s_add_u32 s63, s62, 507904
    v_mov_b32 v140, -1
    v_mov_b32 v141, -1
    v_mov_b32 v142, -1
    v_mov_b32 v143, -1
    buffer_store_dwordx4 v[136:139], v166, s[40:43], s62 offen
    buffer_store_dwordx4 v[140:143], v166, s[40:43], s63 offen
    s_branch L_qwait
L_V:
    s_load_dwordx4 s[20:23], s[0:1], 64
    s_load_dwordx2 s[24:25], s[0:1], 80
    v_lshlrev_b32 v4, 4, v3
    v_bfe_u32 v5, v0, 4, 2
    v_lshl_add_u32 v1, v5, 12, v4
    s_waitcnt lgkmcnt(0)
    s_barrier
    s_add_u32 s32, s8, s49
    s_addc_u32 s33, s9, 0
    s_mov_b32 s34, 0x20000
    s_mov_b32 s35, 0x20000
    s_cmp_lg_u32 s31, 3
    s_cbranch_scc1 L_Vgo
L_w3:
    ds_read_b32 v5, v6 offset:32
    s_waitcnt lgkmcnt(0)
    v_readfirstlane_b32 s44, v5
    s_nop 0
    s_cmp_ge_u32 s44, 3
    s_cbranch_scc1 L_d4
    s_sleep 1
    s_sub_u32 s50, s50, 1
    s_cbranch_scc0 L_w3
    s_endpgm
L_d4:
    buffer_load_dwordx4 v[40:43], v1, s[32:35], s62 offen offset:0 nt
    s_nop 0
    buffer_load_dwordx4 v[44:47], v1, s[32:35], s62 offen offset:1024 nt
    s_nop 0
    buffer_load_dwordx4 v[48:51], v1, s[32:35], s62 offen offset:2048 nt
    s_nop 0
    buffer_load_dwordx4 v[52:55], v1, s[32:35], s62 offen offset:3072 nt
    s_movk_i32 s62, 16384
    buffer_load_dwordx4 v[56:59], v1, s[32:35], s62 offen offset:0 nt
    s_nop 0
    buffer_load_dwordx4 v[60:63], v1, s[32:35], s62 offen offset:1024 nt
    s_nop 0
    buffer_load_dwordx4 v[64:67], v1, s[32:35], s62 offen offset:2048 nt
    s_nop 0
    buffer_load_dwordx4 v[68:71], v1, s[32:35], s62 offen offset:3072 nt
    s_mov_b32 s62, 32768
    buffer_load_dwordx4 v[72:75], v1, s[32:35], s62 offen offset:0 nt
    s_nop 0
    buffer_load_dwordx4 v[76:79], v1, s[32:35], s62 offen offset:1024 nt
    s_nop 0
    buffer_load_dwordx4 v[80:83], v1, s[32:35], s62 offen offset:2048 nt
    s_nop 0
    buffer_load_dwordx4 v[84:87], v1, s[32:35], s62 offen offset:3072 nt
    s_mov_b32 s62, 49152
    buffer_load_dwordx4 v[88:91], v1, s[32:35], s62 offen offset:0 nt
    s_nop 0
    buffer_load_dwordx4 v[92:95], v1, s[32:35], s62 offen offset:1024 nt
    s_nop 0
    buffer_load_dwordx4 v[96:99], v1, s[32:35], s62 offen offset:2048 nt
    s_nop 0
    buffer_load_dwordx4 v[100:103], v1, s[32:35], s62 offen offset:3072 nt
    s_mov_b32 s62, 65536
    buffer_load_dwordx4 v[104:107], v1, s[32:35], s62 offen offset:0 nt
    s_nop 0
    buffer_load_dwordx4 v[108:111], v1, s[32:35], s62 offen offset:1024 nt
    s_nop 0
    buffer_load_dwordx4 v[112:115], v1, s[32:35], s62 offen offset:2048 nt
    s_nop 0
    buffer_load_dwordx4 v[116:119], v1, s[32:35], s62 offen offset:3072 nt
    s_mov_b32 s62, 81920
    buffer_load_dwordx4 v[120:123], v1, s[32:35], s62 offen offset:0 nt
    s_nop 0
    buffer_load_dwordx4 v[124:127], v1, s[32:35], s62 offen offset:1024 nt
    s_nop 0
    buffer_load_dwordx4 v[128:131], v1, s[32:35], s62 offen offset:2048 nt
    s_nop 0
    buffer_load_dwordx4 v[132:135], v1, s[32:35], s62 offen offset:3072 nt
    s_mov_b32 s62, 98304
    buffer_load_dwordx4 v[136:139], v1, s[32:35], s62 offen offset:0 nt
    s_nop 0
    buffer_load_dwordx4 v[140:143], v1, s[32:35], s62 offen offset:1024 nt
    s_nop 0
    buffer_load_dwordx4 v[144:147], v1, s[32:35], s62 offen offset:2048 nt
    s_nop 0
    buffer_load_dwordx4 v[148:151], v1, s[32:35], s62 offen offset:3072 nt
    s_mov_b32 s62, 114688
    buffer_load_dwordx4 v[152:155], v1, s[32:35], s62 offen offset:0 nt
    s_nop 0
    buffer_load_dwordx4 v[156:159], v1, s[32:35], s62 offen offset:1024 nt
    s_nop 0
    buffer_load_dwordx4 v[160:163], v1, s[32:35], s62 offen offset:2048 nt
    s_nop 0
    buffer_load_dwordx4 v[164:167], v1, s[32:35], s62 offen offset:3072 nt
    s_mov_b64 exec, 1
    ds_add_u32 v6, v7 offset:52
    s_mov_b64 exec, -1
    s_branch L_Vissued
L_Vgo:
L_w5:
    ds_read_b32 v5, v6 offset:60
    s_waitcnt lgkmcnt(0)
    v_readfirstlane_b32 s44, v5
    s_nop 0
    s_cmp_ge_u32 s44, 4
    s_cbranch_scc1 L_d6
    s_sleep 1
    s_sub_u32 s50, s50, 1
    s_cbranch_scc0 L_w5
    s_endpgm
L_d6:
    buffer_load_dwordx4 v[40:43], v1, s[32:35], s62 offen offset:0 nt
    s_nop 0
    buffer_load_dwordx4 v[44:47], v1, s[32:35], s62 offen offset:1024 nt
    s_nop 0
    buffer_load_dwordx4 v[48:51], v1, s[32:35], s62 offen offset:2048 nt
    s_nop 0
    buffer_load_dwordx4 v[52:55], v1, s[32:35], s62 offen offset:3072 nt
    s_movk_i32 s62, 16384
    buffer_load_dwordx4 v[56:59], v1, s[32:35], s62 offen offset:0 nt
    s_nop 0
    buffer_load_dwordx4 v[60:63], v1, s[32:35], s62 offen offset:1024 nt
    s_nop 0
    buffer_load_dwordx4 v[64:67], v1, s[32:35], s62 offen offset:2048 nt
    s_nop 0
    buffer_load_dwordx4 v[68:71], v1, s[32:35], s62 offen offset:3072 nt
    s_mov_b32 s62, 32768
    buffer_load_dwordx4 v[72:75], v1, s[32:35], s62 offen offset:0 nt
    s_nop 0
    buffer_load_dwordx4 v[76:79], v1, s[32:35], s62 offen offset:1024 nt
    s_nop 0
    buffer_load_dwordx4 v[80:83], v1, s[32:35], s62 offen offset:2048 nt
    s_nop 0
    buffer_load_dwordx4 v[84:87], v1, s[32:35], s62 offen offset:3072 nt
    s_mov_b32 s62, 49152
    buffer_load_dwordx4 v[88:91], v1, s[32:35], s62 offen offset:0 nt
    s_nop 0
    buffer_load_dwordx4 v[92:95], v1, s[32:35], s62 offen offset:1024 nt
    s_nop 0
    buffer_load_dwordx4 v[96:99], v1, s[32:35], s62 offen offset:2048 nt
    s_nop 0
    buffer_load_dwordx4 v[100:103], v1, s[32:35], s62 offen offset:3072 nt
    s_mov_b32 s62, 65536
    buffer_load_dwordx4 v[104:107], v1, s[32:35], s62 offen offset:0 nt
    s_nop 0
    buffer_load_dwordx4 v[108:111], v1, s[32:35], s62 offen offset:1024 nt
    s_nop 0
    buffer_load_dwordx4 v[112:115], v1, s[32:35], s62 offen offset:2048 nt
    s_nop 0
    buffer_load_dwordx4 v[116:119], v1, s[32:35], s62 offen offset:3072 nt
    s_mov_b32 s62, 81920
    buffer_load_dwordx4 v[120:123], v1, s[32:35], s62 offen offset:0 nt
    s_nop 0
    buffer_load_dwordx4 v[124:127], v1, s[32:35], s62 offen offset:1024 nt
    s_nop 0
    buffer_load_dwordx4 v[128:131], v1, s[32:35], s62 offen offset:2048 nt
    s_nop 0
    buffer_load_dwordx4 v[132:135], v1, s[32:35], s62 offen offset:3072 nt
    s_mov_b32 s62, 98304
    buffer_load_dwordx4 v[136:139], v1, s[32:35], s62 offen offset:0 nt
    s_nop 0
    buffer_load_dwordx4 v[140:143], v1, s[32:35], s62 offen offset:1024 nt
    s_nop 0
    buffer_load_dwordx4 v[144:147], v1, s[32:35], s62 offen offset:2048 nt
    s_nop 0
    buffer_load_dwordx4 v[148:151], v1, s[32:35], s62 offen offset:3072 nt
    s_mov_b32 s62, 114688
    buffer_load_dwordx4 v[152:155], v1, s[32:35], s62 offen offset:0 nt
    s_nop 0
    buffer_load_dwordx4 v[156:159], v1, s[32:35], s62 offen offset:1024 nt
    s_nop 0
    buffer_load_dwordx4 v[160:163], v1, s[32:35], s62 offen offset:2048 nt
    s_nop 0
    buffer_load_dwordx4 v[164:167], v1, s[32:35], s62 offen offset:3072 nt
L_Vissued:
    s_mov_b64 exec, 1
    ds_add_u32 v6, v7 offset:32
    s_mov_b64 exec, -1
    s_mov_b32 s51, 0x05040100
    s_mov_b32 s52, 0x07060302
    s_mov_b32 s54, 0xf000f
    s_mov_b32 s55, 0xf000f
    s_mov_b32 s56, 0xf000f0
    s_mov_b32 s57, 0xf000f0
    s_mov_b32 s58, 0xf000f00
    s_mov_b32 s59, 0xf000f00
    s_mov_b32 s60, 0xf000f000
    s_mov_b32 s61, 0xf000f000
    s_mov_b32 s40, s24
    s_mov_b32 s41, s25
    s_mov_b32 s42, 0x400000
    s_mov_b32 s43, 0x20000
    v_and_b32 v3, 3, v0
    v_lshlrev_b32 v3, 8, v3
    v_lshl_add_u32 v3, v2, 4, v3
    s_lshl_b32 s45, s31, 10
    s_add_u32 s45, s45, 1536
    v_add_u32 v1, s45, v3
    v_mov_b32 v24, 128
    v_cndmask_b32 v2, v24, v1, s[54:55]
    v_cndmask_b32 v3, v24, v1, s[56:57]
    v_cndmask_b32 v4, v24, v1, s[58:59]
    v_cndmask_b32 v5, v24, v1, s[60:61]
    s_lshl_b32 s45, s31, 2
    v_mov_b32 v24, s45
L_w7:
    ds_read_b32 v25, v24 offset:16
    s_waitcnt lgkmcnt(0)
    v_readfirstlane_b32 s44, v25
    s_nop 0
    s_cmp_ge_u32 s44, 1
    s_cbranch_scc1 L_d8
    s_sleep 2
    s_sub_u32 s50, s50, 1
    s_cbranch_scc0 L_w7
    s_endpgm
L_d8:
    ds_read_b128 v[8:11], v2 offset:0
    ds_read_b128 v[12:15], v3 offset:0
    ds_read_b128 v[16:19], v4 offset:0
    ds_read_b128 v[20:23], v5 offset:0
    s_waitcnt vmcnt(24) lgkmcnt(0)
    v_perm_b32 v24, v44, v40, s51
    v_perm_b32 v25, v52, v48, s51
    v_perm_b32 v26, v60, v56, s51
    v_perm_b32 v27, v68, v64, s51
    v_perm_b32 v28, v44, v40, s52
    v_perm_b32 v29, v52, v48, s52
    v_perm_b32 v30, v60, v56, s52
    v_perm_b32 v31, v68, v64, s52
    v_mfma_f32_16x16x32_bf16 v[32:35], v[8:11], v[24:27], 0
    v_perm_b32 v24, v45, v41, s51
    v_perm_b32 v25, v53, v49, s51
    v_perm_b32 v26, v61, v57, s51
    v_perm_b32 v27, v69, v65, s51
    v_mfma_f32_16x16x32_bf16 v[36:39], v[8:11], v[28:31], 0
    v_perm_b32 v28, v45, v41, s52
    v_perm_b32 v29, v53, v49, s52
    v_perm_b32 v30, v61, v57, s52
    v_perm_b32 v31, v69, v65, s52
    v_mfma_f32_16x16x32_bf16 v[32:35], v[12:15], v[24:27], v[32:35]
    v_perm_b32 v24, v46, v42, s51
    v_perm_b32 v25, v54, v50, s51
    v_perm_b32 v26, v62, v58, s51
    v_perm_b32 v27, v70, v66, s51
    v_mfma_f32_16x16x32_bf16 v[36:39], v[12:15], v[28:31], v[36:39]
    v_perm_b32 v28, v46, v42, s52
    v_perm_b32 v29, v54, v50, s52
    v_perm_b32 v30, v62, v58, s52
    v_perm_b32 v31, v70, v66, s52
    v_mfma_f32_16x16x32_bf16 v[32:35], v[16:19], v[24:27], v[32:35]
    v_perm_b32 v24, v47, v43, s51
    v_perm_b32 v25, v55, v51, s51
    v_perm_b32 v26, v63, v59, s51
    v_perm_b32 v27, v71, v67, s51
    v_mfma_f32_16x16x32_bf16 v[36:39], v[16:19], v[28:31], v[36:39]
    v_perm_b32 v28, v47, v43, s52
    v_perm_b32 v29, v55, v51, s52
    v_perm_b32 v30, v63, v59, s52
    v_perm_b32 v31, v71, v67, s52
    v_mfma_f32_16x16x32_bf16 v[32:35], v[20:23], v[24:27], v[32:35]
    s_nop 0
    v_mfma_f32_16x16x32_bf16 v[36:39], v[20:23], v[28:31], v[36:39]
    ds_read_b128 v[8:11], v2 offset:64
    ds_read_b128 v[12:15], v3 offset:64
    ds_read_b128 v[16:19], v4 offset:64
    ds_read_b128 v[20:23], v5 offset:64
    s_waitcnt vmcnt(16) lgkmcnt(0)
    v_perm_b32 v24, v76, v72, s51
    v_perm_b32 v25, v84, v80, s51
    v_perm_b32 v26, v92, v88, s51
    v_perm_b32 v27, v100, v96, s51
    v_perm_b32 v28, v76, v72, s52
    v_perm_b32 v29, v84, v80, s52
    v_perm_b32 v30, v92, v88, s52
    v_perm_b32 v31, v100, v96, s52
    v_mfma_f32_16x16x32_bf16 v[32:35], v[8:11], v[24:27], v[32:35]
    v_perm_b32 v24, v77, v73, s51
    v_perm_b32 v25, v85, v81, s51
    v_perm_b32 v26, v93, v89, s51
    v_perm_b32 v27, v101, v97, s51
    v_mfma_f32_16x16x32_bf16 v[36:39], v[8:11], v[28:31], v[36:39]
    v_perm_b32 v28, v77, v73, s52
    v_perm_b32 v29, v85, v81, s52
    v_perm_b32 v30, v93, v89, s52
    v_perm_b32 v31, v101, v97, s52
    v_mfma_f32_16x16x32_bf16 v[32:35], v[12:15], v[24:27], v[32:35]
    v_perm_b32 v24, v78, v74, s51
    v_perm_b32 v25, v86, v82, s51
    v_perm_b32 v26, v94, v90, s51
    v_perm_b32 v27, v102, v98, s51
    v_mfma_f32_16x16x32_bf16 v[36:39], v[12:15], v[28:31], v[36:39]
    v_perm_b32 v28, v78, v74, s52
    v_perm_b32 v29, v86, v82, s52
    v_perm_b32 v30, v94, v90, s52
    v_perm_b32 v31, v102, v98, s52
    v_mfma_f32_16x16x32_bf16 v[32:35], v[16:19], v[24:27], v[32:35]
    v_perm_b32 v24, v79, v75, s51
    v_perm_b32 v25, v87, v83, s51
    v_perm_b32 v26, v95, v91, s51
    v_perm_b32 v27, v103, v99, s51
    v_mfma_f32_16x16x32_bf16 v[36:39], v[16:19], v[28:31], v[36:39]
    v_perm_b32 v28, v79, v75, s52
    v_perm_b32 v29, v87, v83, s52
    v_perm_b32 v30, v95, v91, s52
    v_perm_b32 v31, v103, v99, s52
    v_mfma_f32_16x16x32_bf16 v[32:35], v[20:23], v[24:27], v[32:35]
    s_nop 0
    v_mfma_f32_16x16x32_bf16 v[36:39], v[20:23], v[28:31], v[36:39]
    ds_read_b128 v[8:11], v2 offset:128
    ds_read_b128 v[12:15], v3 offset:128
    ds_read_b128 v[16:19], v4 offset:128
    ds_read_b128 v[20:23], v5 offset:128
    s_waitcnt vmcnt(8) lgkmcnt(0)
    v_perm_b32 v24, v108, v104, s51
    v_perm_b32 v25, v116, v112, s51
    v_perm_b32 v26, v124, v120, s51
    v_perm_b32 v27, v132, v128, s51
    v_perm_b32 v28, v108, v104, s52
    v_perm_b32 v29, v116, v112, s52
    v_perm_b32 v30, v124, v120, s52
    v_perm_b32 v31, v132, v128, s52
    v_mfma_f32_16x16x32_bf16 v[32:35], v[8:11], v[24:27], v[32:35]
    v_perm_b32 v24, v109, v105, s51
    v_perm_b32 v25, v117, v113, s51
    v_perm_b32 v26, v125, v121, s51
    v_perm_b32 v27, v133, v129, s51
    v_mfma_f32_16x16x32_bf16 v[36:39], v[8:11], v[28:31], v[36:39]
    v_perm_b32 v28, v109, v105, s52
    v_perm_b32 v29, v117, v113, s52
    v_perm_b32 v30, v125, v121, s52
    v_perm_b32 v31, v133, v129, s52
    v_mfma_f32_16x16x32_bf16 v[32:35], v[12:15], v[24:27], v[32:35]
    v_perm_b32 v24, v110, v106, s51
    v_perm_b32 v25, v118, v114, s51
    v_perm_b32 v26, v126, v122, s51
    v_perm_b32 v27, v134, v130, s51
    v_mfma_f32_16x16x32_bf16 v[36:39], v[12:15], v[28:31], v[36:39]
    v_perm_b32 v28, v110, v106, s52
    v_perm_b32 v29, v118, v114, s52
    v_perm_b32 v30, v126, v122, s52
    v_perm_b32 v31, v134, v130, s52
    v_mfma_f32_16x16x32_bf16 v[32:35], v[16:19], v[24:27], v[32:35]
    v_perm_b32 v24, v111, v107, s51
    v_perm_b32 v25, v119, v115, s51
    v_perm_b32 v26, v127, v123, s51
    v_perm_b32 v27, v135, v131, s51
    v_mfma_f32_16x16x32_bf16 v[36:39], v[16:19], v[28:31], v[36:39]
    v_perm_b32 v28, v111, v107, s52
    v_perm_b32 v29, v119, v115, s52
    v_perm_b32 v30, v127, v123, s52
    v_perm_b32 v31, v135, v131, s52
    v_mfma_f32_16x16x32_bf16 v[32:35], v[20:23], v[24:27], v[32:35]
    s_nop 0
    v_mfma_f32_16x16x32_bf16 v[36:39], v[20:23], v[28:31], v[36:39]
    s_cmp_eq_u32 s31, 3
    s_cbranch_scc1 L_Vlast
    ds_read_b128 v[8:11], v2 offset:192
    ds_read_b128 v[12:15], v3 offset:192
    ds_read_b128 v[16:19], v4 offset:192
    ds_read_b128 v[20:23], v5 offset:192
    s_waitcnt vmcnt(0) lgkmcnt(0)
    v_perm_b32 v24, v140, v136, s51
    v_perm_b32 v25, v148, v144, s51
    v_perm_b32 v26, v156, v152, s51
    v_perm_b32 v27, v164, v160, s51
    v_perm_b32 v28, v140, v136, s52
    v_perm_b32 v29, v148, v144, s52
    v_perm_b32 v30, v156, v152, s52
    v_perm_b32 v31, v164, v160, s52
    v_mfma_f32_16x16x32_bf16 v[32:35], v[8:11], v[24:27], v[32:35]
    v_perm_b32 v24, v141, v137, s51
    v_perm_b32 v25, v149, v145, s51
    v_perm_b32 v26, v157, v153, s51
    v_perm_b32 v27, v165, v161, s51
    v_mfma_f32_16x16x32_bf16 v[36:39], v[8:11], v[28:31], v[36:39]
    v_perm_b32 v28, v141, v137, s52
    v_perm_b32 v29, v149, v145, s52
    v_perm_b32 v30, v157, v153, s52
    v_perm_b32 v31, v165, v161, s52
    v_mfma_f32_16x16x32_bf16 v[32:35], v[12:15], v[24:27], v[32:35]
    v_perm_b32 v24, v142, v138, s51
    v_perm_b32 v25, v150, v146, s51
    v_perm_b32 v26, v158, v154, s51
    v_perm_b32 v27, v166, v162, s51
    v_mfma_f32_16x16x32_bf16 v[36:39], v[12:15], v[28:31], v[36:39]
    v_perm_b32 v28, v142, v138, s52
    v_perm_b32 v29, v150, v146, s52
    v_perm_b32 v30, v158, v154, s52
    v_perm_b32 v31, v166, v162, s52
    v_mfma_f32_16x16x32_bf16 v[32:35], v[16:19], v[24:27], v[32:35]
    v_perm_b32 v24, v143, v139, s51
    v_perm_b32 v25, v151, v147, s51
    v_perm_b32 v26, v159, v155, s51
    v_perm_b32 v27, v167, v163, s51
    v_mfma_f32_16x16x32_bf16 v[36:39], v[16:19], v[28:31], v[36:39]
    v_perm_b32 v28, v143, v139, s52
    v_perm_b32 v29, v151, v147, s52
    v_perm_b32 v30, v159, v155, s52
    v_perm_b32 v31, v167, v163, s52
    v_mfma_f32_16x16x32_bf16 v[32:35], v[20:23], v[24:27], v[32:35]
    s_nop 0
    v_mfma_f32_16x16x32_bf16 v[36:39], v[20:23], v[28:31], v[36:39]
    s_lshl_b32 s45, s31, 11
    v_lshlrev_b32 v1, 4, v0
    v_add_u32 v1, s45, v1
    s_nop 2
    ds_write_b128 v1, v[32:35] offset:5632
    s_nop 0
    ds_write_b128 v1, v[36:39] offset:6656
    s_mov_b64 exec, 1
    ds_add_u32 v6, v7 offset:36
    s_mov_b64 exec, -1
    s_endpgm
L_Vlast:
    s_setprio 3
    v_lshlrev_b32 v95, 4, v0
    s_lshl_b32 s45, s27, 5
    s_add_u32 s45, s45, s28
    s_lshl_b32 s45, s45, 10
    s_add_u32 s49, s45, 1310720
    ds_read_b32 v94, v6 offset:4
    s_waitcnt lgkmcnt(0)
    v_readfirstlane_b32 s79, v94
L_w9:
    ds_read_b32 v94, v6 offset:36
    s_waitcnt lgkmcnt(0)
    v_readfirstlane_b32 s44, v94
    s_nop 0
    s_cmp_ge_u32 s44, 3
    s_cbranch_scc1 L_d10
    s_sleep 1
    s_sub_u32 s50, s50, 1
    s_cbranch_scc0 L_w9
    s_endpgm
L_d10:
L_w11:
    ds_read_b32 v94, v6 offset:40
    s_waitcnt lgkmcnt(0)
    v_readfirstlane_b32 s44, v94
    s_nop 0
    s_cmp_ge_u32 s44, 1
    s_cbranch_scc1 L_d12
    s_sleep 1
    s_sub_u32 s50, s50, 1
    s_cbranch_scc0 L_w11
    s_endpgm
L_d12:
    ds_read_b128 v[40:43], v95 offset:5632
    ds_read_b128 v[44:47], v95 offset:6656
    ds_read_b128 v[48:51], v95 offset:7680
    ds_read_b128 v[52:55], v95 offset:8704
    ds_read_b128 v[56:59], v95 offset:9728
    ds_read_b128 v[60:63], v95 offset:10752
    ds_read_b128 v[64:67], v6 offset:384
    ds_read_b128 v[68:71], v6 offset:400
    ds_read_b128 v[72:75], v6 offset:416
    ds_read_b128 v[76:79], v6 offset:432
    s_waitcnt lgkmcnt(0)
    v_mul_f32 v80, v64, v40
    v_mul_f32 v81, v65, v41
    v_mul_f32 v82, v66, v42
    v_mul_f32 v83, v67, v43
    v_mul_f32 v84, v64, v44
    v_mul_f32 v85, v65, v45
    v_mul_f32 v86, v66, v46
    v_mul_f32 v87, v67, v47
    v_fmac_f32 v80, v68, v48
    v_fmac_f32 v81, v69, v49
    v_fmac_f32 v82, v70, v50
    v_fmac_f32 v83, v71, v51
    v_fmac_f32 v84, v68, v52
    v_fmac_f32 v85, v69, v53
    v_fmac_f32 v86, v70, v54
    v_fmac_f32 v87, v71, v55
    v_fmac_f32 v80, v72, v56
    v_fmac_f32 v81, v73, v57
    v_fmac_f32 v82, v74, v58
    v_fmac_f32 v83, v75, v59
    v_fmac_f32 v84, v72, v60
    v_fmac_f32 v85, v73, v61
    v_fmac_f32 v86, v74, v62
    v_fmac_f32 v87, v75, v63
    ds_read_b128 v[8:11], v2 offset:192
    ds_read_b128 v[12:15], v3 offset:192
    ds_read_b128 v[16:19], v4 offset:192
    ds_read_b128 v[20:23], v5 offset:192
    s_waitcnt vmcnt(6)
    v_perm_b32 v96, v140, v136, s51
    v_perm_b32 v100, v140, v136, s52
    v_perm_b32 v104, v141, v137, s51
    v_perm_b32 v108, v141, v137, s52
    v_perm_b32 v112, v142, v138, s51
    v_perm_b32 v116, v142, v138, s52
    v_perm_b32 v120, v143, v139, s51
    v_perm_b32 v124, v143, v139, s52
    s_waitcnt vmcnt(4)
    v_perm_b32 v97, v148, v144, s51
    v_perm_b32 v101, v148, v144, s52
    v_perm_b32 v105, v149, v145, s51
    v_perm_b32 v109, v149, v145, s52
    v_perm_b32 v113, v150, v146, s51
    v_perm_b32 v117, v150, v146, s52
    v_perm_b32 v121, v151, v147, s51
    v_perm_b32 v125, v151, v147, s52
    s_waitcnt vmcnt(2)
    v_perm_b32 v98, v156, v152, s51
    v_perm_b32 v102, v156, v152, s52
    v_perm_b32 v106, v157, v153, s51
    v_perm_b32 v110, v157, v153, s52
    v_perm_b32 v114, v158, v154, s51
    v_perm_b32 v118, v158, v154, s52
    v_perm_b32 v122, v159, v155, s51
    v_perm_b32 v126, v159, v155, s52
    s_waitcnt vmcnt(0) lgkmcnt(0)
    v_perm_b32 v99, v164, v160, s51
    v_perm_b32 v103, v164, v160, s52
    v_perm_b32 v107, v165, v161, s51
    v_mfma_f32_16x16x32_bf16 v[32:35], v[8:11], v[96:99], v[32:35]
    v_perm_b32 v111, v165, v161, s52
    v_mfma_f32_16x16x32_bf16 v[36:39], v[8:11], v[100:103], v[36:39]
    v_perm_b32 v115, v166, v162, s51
    v_mfma_f32_16x16x32_bf16 v[32:35], v[12:15], v[104:107], v[32:35]
    v_perm_b32 v119, v166, v162, s52
    v_mfma_f32_16x16x32_bf16 v[36:39], v[12:15], v[108:111], v[36:39]
    v_perm_b32 v123, v167, v163, s51
    v_mfma_f32_16x16x32_bf16 v[32:35], v[16:19], v[112:115], v[32:35]
    v_perm_b32 v127, v167, v163, s52
    v_mfma_f32_16x16x32_bf16 v[36:39], v[16:19], v[116:119], v[36:39]
    v_mfma_f32_16x16x32_bf16 v[32:35], v[20:23], v[120:123], v[32:35]
    v_mfma_f32_16x16x32_bf16 v[36:39], v[20:23], v[124:127], v[36:39]
    s_nop 6
    v_fmac_f32 v80, v76, v32
    v_fmac_f32 v81, v77, v33
    v_fmac_f32 v82, v78, v34
    v_fmac_f32 v83, v79, v35
    v_fmac_f32 v84, v76, v36
    v_fmac_f32 v85, v77, v37
    v_fmac_f32 v86, v78, v38
    v_fmac_f32 v87, v79, v39
    v_cvt_pk_bf16_f32 v24, v80, v84
    v_cvt_pk_bf16_f32 v25, v81, v85
    v_cvt_pk_bf16_f32 v26, v82, v86
    v_cvt_pk_bf16_f32 v27, v83, v87
    s_nop 0
    v_permlane32_swap_b32 v24, v26
    v_permlane32_swap_b32 v25, v27
    s_nop 1
    v_permlane16_swap_b32 v24, v25
    v_permlane16_swap_b32 v26, v27
    v_min_u32 v24, 0xfffffffe, v24
    v_min_u32 v25, 0xfffffffe, v25
    v_min_u32 v26, 0xfffffffe, v26
    v_min_u32 v27, 0xfffffffe, v27
    s_cmp_lg_u32 s79, 0
    s_cbranch_scc1 L_s13
    buffer_store_dwordx4 v[24:27], v95, s[40:43], s49 offen
    s_branch L_d14
L_s13:
    buffer_store_dwordx4 v[24:27], v95, s[40:43], s49 offen sc1
L_d14:
    s_endpgm
L_K2:
    s_mov_b32 s74, 0xaaaaaaaa
    s_mov_b32 s75, 0xaaaaaaaa
    s_mov_b32 s76, 0xcccccccc
    s_mov_b32 s77, 0xcccccccc
    v_lshlrev_b32 v37, 8, v2
    v_lshl_add_u32 v37, v3, 2, v37
    s_lshl_b32 s45, s31, 10
    v_add_u32 v37, s45, v37
    v_lshlrev_b32 v38, 3, v2
    s_lshl_b32 s45, s31, 5
    v_add_u32 v38, s45, v38
    s_lshl_b32 s45, s31, 2
    v_mov_b32 v39, s45
L_w1:
    ds_read_b32 v5, v6 offset:8
    s_waitcnt lgkmcnt(0)
    v_readfirstlane_b32 s44, v5
    s_nop 0
    s_cmp_ge_u32 s44, 4
    s_cbranch_scc1 L_d2
    s_sleep 2
    s_sub_u32 s50, s50, 1
    s_cbranch_scc0 L_w1
    s_endpgm
L_d2:
    ds_read_b128 v[8:11], v36 offset:512
    s_waitcnt vmcnt(0) lgkmcnt(0)
    v_mfma_f32_16x16x32_bf16 v[12:15], v[8:11], v[40:43], 0
    v_mfma_f32_16x16x32_bf16 v[16:19], v[8:11], v[44:47], 0
    v_mfma_f32_16x16x32_bf16 v[20:23], v[8:11], v[48:51], 0
    v_mfma_f32_16x16x32_bf16 v[24:27], v[8:11], v[52:55], 0
    v_mfma_f32_16x16x32_bf16 v[40:43], v[8:11], v[56:59], 0
    v_mfma_f32_16x16x32_bf16 v[44:47], v[8:11], v[60:63], 0
    v_mfma_f32_16x16x32_bf16 v[48:51], v[8:11], v[64:67], 0
    v_mfma_f32_16x16x32_bf16 v[52:55], v[8:11], v[68:71], 0
    s_nop 0
    v_mov_b32_dpp v28, v12 quad_perm:[0,0,0,0] row_mask:0xf bank_mask:0xf
    v_mov_b32_dpp v29, v16 quad_perm:[0,0,0,0] row_mask:0xf bank_mask:0xf
    v_mov_b32_dpp v30, v20 quad_perm:[0,0,0,0] row_mask:0xf bank_mask:0xf
    v_mov_b32_dpp v31, v24 quad_perm:[0,0,0,0] row_mask:0xf bank_mask:0xf
    v_add_f32_dpp v28, v13, v28 quad_perm:[1,1,1,1] row_mask:0xf bank_mask:0xf
    v_add_f32_dpp v29, v17, v29 quad_perm:[1,1,1,1] row_mask:0xf bank_mask:0xf
    v_add_f32_dpp v30, v21, v30 quad_perm:[1,1,1,1] row_mask:0xf bank_mask:0xf
    v_add_f32_dpp v31, v25, v31 quad_perm:[1,1,1,1] row_mask:0xf bank_mask:0xf
    v_add_f32_dpp v28, v14, v28 quad_perm:[2,2,2,2] row_mask:0xf bank_mask:0xf
    v_add_f32_dpp v29, v18, v29 quad_perm:[2,2,2,2] row_mask:0xf bank_mask:0xf
    v_add_f32_dpp v30, v22, v30 quad_perm:[2,2,2,2] row_mask:0xf bank_mask:0xf
    v_add_f32_dpp v31, v26, v31 quad_perm:[2,2,2,2] row_mask:0xf bank_mask:0xf
    v_add_f32_dpp v28, v15, v28 quad_perm:[3,3,3,3] row_mask:0xf bank_mask:0xf
    v_add_f32_dpp v29, v19, v29 quad_perm:[3,3,3,3] row_mask:0xf bank_mask:0xf
    v_add_f32_dpp v30, v23, v30 quad_perm:[3,3,3,3] row_mask:0xf bank_mask:0xf
    v_add_f32_dpp v31, v27, v31 quad_perm:[3,3,3,3] row_mask:0xf bank_mask:0xf
    v_cndmask_b32 v28, v28, v29, s[74:75]
    v_cndmask_b32 v30, v30, v31, s[74:75]
    v_cndmask_b32 v32, v28, v30, s[76:77]
    v_mfma_f32_16x16x32_bf16 v[56:59], v[8:11], v[72:75], 0
    v_mfma_f32_16x16x32_bf16 v[60:63], v[8:11], v[76:79], 0
    v_mfma_f32_16x16x32_bf16 v[64:67], v[8:11], v[80:83], 0
    v_mfma_f32_16x16x32_bf16 v[68:71], v[8:11], v[84:87], 0
    v_mov_b32_dpp v28, v40 quad_perm:[0,0,0,0] row_mask:0xf bank_mask:0xf
    v_mov_b32_dpp v29, v44 quad_perm:[0,0,0,0] row_mask:0xf bank_mask:0xf
    v_mov_b32_dpp v30, v48 quad_perm:[0,0,0,0] row_mask:0xf bank_mask:0xf
    v_mov_b32_dpp v31, v52 quad_perm:[0,0,0,0] row_mask:0xf bank_mask:0xf
    v_add_f32_dpp v28, v41, v28 quad_perm:[1,1,1,1] row_mask:0xf bank_mask:0xf
    v_add_f32_dpp v29, v45, v29 quad_perm:[1,1,1,1] row_mask:0xf bank_mask:0xf
    v_add_f32_dpp v30, v49, v30 quad_perm:[1,1,1,1] row_mask:0xf bank_mask:0xf
    v_add_f32_dpp v31, v53, v31 quad_perm:[1,1,1,1] row_mask:0xf bank_mask:0xf
    v_add_f32_dpp v28, v42, v28 quad_perm:[2,2,2,2] row_mask:0xf bank_mask:0xf
    v_add_f32_dpp v29, v46, v29 quad_perm:[2,2,2,2] row_mask:0xf bank_mask:0xf
    v_add_f32_dpp v30, v50, v30 quad_perm:[2,2,2,2] row_mask:0xf bank_mask:0xf
    v_add_f32_dpp v31, v54, v31 quad_perm:[2,2,2,2] row_mask:0xf bank_mask:0xf
    v_add_f32_dpp v28, v43, v28 quad_perm:[3,3,3,3] row_mask:0xf bank_mask:0xf
    v_add_f32_dpp v29, v47, v29 quad_perm:[3,3,3,3] row_mask:0xf bank_mask:0xf
    v_add_f32_dpp v30, v51, v30 quad_perm:[3,3,3,3] row_mask:0xf bank_mask:0xf
    v_add_f32_dpp v31, v55, v31 quad_perm:[3,3,3,3] row_mask:0xf bank_mask:0xf
    v_cndmask_b32 v28, v28, v29, s[74:75]
    v_cndmask_b32 v30, v30, v31, s[74:75]
    v_cndmask_b32 v33, v28, v30, s[76:77]
    v_mfma_f32_16x16x32_bf16 v[72:75], v[8:11], v[88:91], 0
    v_mfma_f32_16x16x32_bf16 v[76:79], v[8:11], v[92:95], 0
    v_mfma_f32_16x16x32_bf16 v[80:83], v[8:11], v[96:99], 0
    v_mfma_f32_16x16x32_bf16 v[84:87], v[8:11], v[100:103], 0
    v_mov_b32_dpp v28, v56 quad_perm:[0,0,0,0] row_mask:0xf bank_mask:0xf
    v_mov_b32_dpp v29, v60 quad_perm:[0,0,0,0] row_mask:0xf bank_mask:0xf
    v_mov_b32_dpp v30, v64 quad_perm:[0,0,0,0] row_mask:0xf bank_mask:0xf
    v_mov_b32_dpp v31, v68 quad_perm:[0,0,0,0] row_mask:0xf bank_mask:0xf
    v_add_f32_dpp v28, v57, v28 quad_perm:[1,1,1,1] row_mask:0xf bank_mask:0xf
    v_add_f32_dpp v29, v61, v29 quad_perm:[1,1,1,1] row_mask:0xf bank_mask:0xf
    v_add_f32_dpp v30, v65, v30 quad_perm:[1,1,1,1] row_mask:0xf bank_mask:0xf
    v_add_f32_dpp v31, v69, v31 quad_perm:[1,1,1,1] row_mask:0xf bank_mask:0xf
    v_add_f32_dpp v28, v58, v28 quad_perm:[2,2,2,2] row_mask:0xf bank_mask:0xf
    v_add_f32_dpp v29, v62, v29 quad_perm:[2,2,2,2] row_mask:0xf bank_mask:0xf
    v_add_f32_dpp v30, v66, v30 quad_perm:[2,2,2,2] row_mask:0xf bank_mask:0xf
    v_add_f32_dpp v31, v70, v31 quad_perm:[2,2,2,2] row_mask:0xf bank_mask:0xf
    v_add_f32_dpp v28, v59, v28 quad_perm:[3,3,3,3] row_mask:0xf bank_mask:0xf
    v_add_f32_dpp v29, v63, v29 quad_perm:[3,3,3,3] row_mask:0xf bank_mask:0xf
    v_add_f32_dpp v30, v67, v30 quad_perm:[3,3,3,3] row_mask:0xf bank_mask:0xf
    v_add_f32_dpp v31, v71, v31 quad_perm:[3,3,3,3] row_mask:0xf bank_mask:0xf
    v_cndmask_b32 v28, v28, v29, s[74:75]
    v_cndmask_b32 v30, v30, v31, s[74:75]
    v_cndmask_b32 v34, v28, v30, s[76:77]
    v_mfma_f32_16x16x32_bf16 v[88:91], v[8:11], v[104:107], 0
    v_mfma_f32_16x16x32_bf16 v[92:95], v[8:11], v[108:111], 0
    v_mfma_f32_16x16x32_bf16 v[96:99], v[8:11], v[112:115], 0
    v_mfma_f32_16x16x32_bf16 v[100:103], v[8:11], v[116:119], 0
    v_mov_b32_dpp v28, v72 quad_perm:[0,0,0,0] row_mask:0xf bank_mask:0xf
    v_mov_b32_dpp v29, v76 quad_perm:[0,0,0,0] row_mask:0xf bank_mask:0xf
    v_mov_b32_dpp v30, v80 quad_perm:[0,0,0,0] row_mask:0xf bank_mask:0xf
    v_mov_b32_dpp v31, v84 quad_perm:[0,0,0,0] row_mask:0xf bank_mask:0xf
    v_add_f32_dpp v28, v73, v28 quad_perm:[1,1,1,1] row_mask:0xf bank_mask:0xf
    v_add_f32_dpp v29, v77, v29 quad_perm:[1,1,1,1] row_mask:0xf bank_mask:0xf
    v_add_f32_dpp v30, v81, v30 quad_perm:[1,1,1,1] row_mask:0xf bank_mask:0xf
    v_add_f32_dpp v31, v85, v31 quad_perm:[1,1,1,1] row_mask:0xf bank_mask:0xf
    v_add_f32_dpp v28, v74, v28 quad_perm:[2,2,2,2] row_mask:0xf bank_mask:0xf
    v_add_f32_dpp v29, v78, v29 quad_perm:[2,2,2,2] row_mask:0xf bank_mask:0xf
    v_add_f32_dpp v30, v82, v30 quad_perm:[2,2,2,2] row_mask:0xf bank_mask:0xf
    v_add_f32_dpp v31, v86, v31 quad_perm:[2,2,2,2] row_mask:0xf bank_mask:0xf
    v_add_f32_dpp v28, v75, v28 quad_perm:[3,3,3,3] row_mask:0xf bank_mask:0xf
    v_add_f32_dpp v29, v79, v29 quad_perm:[3,3,3,3] row_mask:0xf bank_mask:0xf
    v_add_f32_dpp v30, v83, v30 quad_perm:[3,3,3,3] row_mask:0xf bank_mask:0xf
    v_add_f32_dpp v31, v87, v31 quad_perm:[3,3,3,3] row_mask:0xf bank_mask:0xf
    v_cndmask_b32 v28, v28, v29, s[74:75]
    v_cndmask_b32 v30, v30, v31, s[74:75]
    v_cndmask_b32 v35, v28, v30, s[76:77]
    v_mfma_f32_16x16x32_bf16 v[104:107], v[8:11], v[120:123], 0
    v_mfma_f32_16x16x32_bf16 v[108:111], v[8:11], v[124:127], 0
    v_mfma_f32_16x16x32_bf16 v[112:115], v[8:11], v[128:131], 0
    v_mfma_f32_16x16x32_bf16 v[116:119], v[8:11], v[132:135], 0
    v_mov_b32_dpp v28, v88 quad_perm:[0,0,0,0] row_mask:0xf bank_mask:0xf
    v_mov_b32_dpp v29, v92 quad_perm:[0,0,0,0] row_mask:0xf bank_mask:0xf
    v_mov_b32_dpp v30, v96 quad_perm:[0,0,0,0] row_mask:0xf bank_mask:0xf
    v_mov_b32_dpp v31, v100 quad_perm:[0,0,0,0] row_mask:0xf bank_mask:0xf
    v_add_f32_dpp v28, v89, v28 quad_perm:[1,1,1,1] row_mask:0xf bank_mask:0xf
    v_add_f32_dpp v29, v93, v29 quad_perm:[1,1,1,1] row_mask:0xf bank_mask:0xf
    v_add_f32_dpp v30, v97, v30 quad_perm:[1,1,1,1] row_mask:0xf bank_mask:0xf
    v_add_f32_dpp v31, v101, v31 quad_perm:[1,1,1,1] row_mask:0xf bank_mask:0xf
    v_add_f32_dpp v28, v90, v28 quad_perm:[2,2,2,2] row_mask:0xf bank_mask:0xf
    v_add_f32_dpp v29, v94, v29 quad_perm:[2,2,2,2] row_mask:0xf bank_mask:0xf
    v_add_f32_dpp v30, v98, v30 quad_perm:[2,2,2,2] row_mask:0xf bank_mask:0xf
    v_add_f32_dpp v31, v102, v31 quad_perm:[2,2,2,2] row_mask:0xf bank_mask:0xf
    v_add_f32_dpp v28, v91, v28 quad_perm:[3,3,3,3] row_mask:0xf bank_mask:0xf
    v_add_f32_dpp v29, v95, v29 quad_perm:[3,3,3,3] row_mask:0xf bank_mask:0xf
    v_add_f32_dpp v30, v99, v30 quad_perm:[3,3,3,3] row_mask:0xf bank_mask:0xf
    v_add_f32_dpp v31, v103, v31 quad_perm:[3,3,3,3] row_mask:0xf bank_mask:0xf
    v_cndmask_b32 v28, v28, v29, s[74:75]
    v_cndmask_b32 v30, v30, v31, s[74:75]
    v_cndmask_b32 v12, v28, v30, s[76:77]
    v_mfma_f32_16x16x32_bf16 v[120:123], v[8:11], v[136:139], 0
    v_mfma_f32_16x16x32_bf16 v[124:127], v[8:11], v[140:143], 0
    v_mfma_f32_16x16x32_bf16 v[128:131], v[8:11], v[144:147], 0
    v_mfma_f32_16x16x32_bf16 v[132:135], v[8:11], v[148:151], 0
    v_mov_b32_dpp v28, v104 quad_perm:[0,0,0,0] row_mask:0xf bank_mask:0xf
    v_mov_b32_dpp v29, v108 quad_perm:[0,0,0,0] row_mask:0xf bank_mask:0xf
    v_mov_b32_dpp v30, v112 quad_perm:[0,0,0,0] row_mask:0xf bank_mask:0xf
    v_mov_b32_dpp v31, v116 quad_perm:[0,0,0,0] row_mask:0xf bank_mask:0xf
    v_add_f32_dpp v28, v105, v28 quad_perm:[1,1,1,1] row_mask:0xf bank_mask:0xf
    v_add_f32_dpp v29, v109, v29 quad_perm:[1,1,1,1] row_mask:0xf bank_mask:0xf
    v_add_f32_dpp v30, v113, v30 quad_perm:[1,1,1,1] row_mask:0xf bank_mask:0xf
    v_add_f32_dpp v31, v117, v31 quad_perm:[1,1,1,1] row_mask:0xf bank_mask:0xf
    v_add_f32_dpp v28, v106, v28 quad_perm:[2,2,2,2] row_mask:0xf bank_mask:0xf
    v_add_f32_dpp v29, v110, v29 quad_perm:[2,2,2,2] row_mask:0xf bank_mask:0xf
    v_add_f32_dpp v30, v114, v30 quad_perm:[2,2,2,2] row_mask:0xf bank_mask:0xf
    v_add_f32_dpp v31, v118, v31 quad_perm:[2,2,2,2] row_mask:0xf bank_mask:0xf
    v_add_f32_dpp v28, v107, v28 quad_perm:[3,3,3,3] row_mask:0xf bank_mask:0xf
    v_add_f32_dpp v29, v111, v29 quad_perm:[3,3,3,3] row_mask:0xf bank_mask:0xf
    v_add_f32_dpp v30, v115, v30 quad_perm:[3,3,3,3] row_mask:0xf bank_mask:0xf
    v_add_f32_dpp v31, v119, v31 quad_perm:[3,3,3,3] row_mask:0xf bank_mask:0xf
    v_cndmask_b32 v28, v28, v29, s[74:75]
    v_cndmask_b32 v30, v30, v31, s[74:75]
    v_cndmask_b32 v13, v28, v30, s[76:77]
    v_mfma_f32_16x16x32_bf16 v[136:139], v[8:11], v[152:155], 0
    v_mfma_f32_16x16x32_bf16 v[140:143], v[8:11], v[156:159], 0
    v_mfma_f32_16x16x32_bf16 v[144:147], v[8:11], v[160:163], 0
    v_mfma_f32_16x16x32_bf16 v[148:151], v[8:11], v[164:167], 0
    v_mov_b32_dpp v28, v120 quad_perm:[0,0,0,0] row_mask:0xf bank_mask:0xf
    v_mov_b32_dpp v29, v124 quad_perm:[0,0,0,0] row_mask:0xf bank_mask:0xf
    v_mov_b32_dpp v30, v128 quad_perm:[0,0,0,0] row_mask:0xf bank_mask:0xf
    v_mov_b32_dpp v31, v132 quad_perm:[0,0,0,0] row_mask:0xf bank_mask:0xf
    v_add_f32_dpp v28, v121, v28 quad_perm:[1,1,1,1] row_mask:0xf bank_mask:0xf
    v_add_f32_dpp v29, v125, v29 quad_perm:[1,1,1,1] row_mask:0xf bank_mask:0xf
    v_add_f32_dpp v30, v129, v30 quad_perm:[1,1,1,1] row_mask:0xf bank_mask:0xf
    v_add_f32_dpp v31, v133, v31 quad_perm:[1,1,1,1] row_mask:0xf bank_mask:0xf
    v_add_f32_dpp v28, v122, v28 quad_perm:[2,2,2,2] row_mask:0xf bank_mask:0xf
    v_add_f32_dpp v29, v126, v29 quad_perm:[2,2,2,2] row_mask:0xf bank_mask:0xf
    v_add_f32_dpp v30, v130, v30 quad_perm:[2,2,2,2] row_mask:0xf bank_mask:0xf
    v_add_f32_dpp v31, v134, v31 quad_perm:[2,2,2,2] row_mask:0xf bank_mask:0xf
    v_add_f32_dpp v28, v123, v28 quad_perm:[3,3,3,3] row_mask:0xf bank_mask:0xf
    v_add_f32_dpp v29, v127, v29 quad_perm:[3,3,3,3] row_mask:0xf bank_mask:0xf
    v_add_f32_dpp v30, v131, v30 quad_perm:[3,3,3,3] row_mask:0xf bank_mask:0xf
    v_add_f32_dpp v31, v135, v31 quad_perm:[3,3,3,3] row_mask:0xf bank_mask:0xf
    v_cndmask_b32 v28, v28, v29, s[74:75]
    v_cndmask_b32 v30, v30, v31, s[74:75]
    v_cndmask_b32 v14, v28, v30, s[76:77]
    v_mov_b32_dpp v28, v136 quad_perm:[0,0,0,0] row_mask:0xf bank_mask:0xf
    v_mov_b32_dpp v29, v140 quad_perm:[0,0,0,0] row_mask:0xf bank_mask:0xf
    v_mov_b32_dpp v30, v144 quad_perm:[0,0,0,0] row_mask:0xf bank_mask:0xf
    v_mov_b32_dpp v31, v148 quad_perm:[0,0,0,0] row_mask:0xf bank_mask:0xf
    v_add_f32_dpp v28, v137, v28 quad_perm:[1,1,1,1] row_mask:0xf bank_mask:0xf
    v_add_f32_dpp v29, v141, v29 quad_perm:[1,1,1,1] row_mask:0xf bank_mask:0xf
    v_add_f32_dpp v30, v145, v30 quad_perm:[1,1,1,1] row_mask:0xf bank_mask:0xf
    v_add_f32_dpp v31, v149, v31 quad_perm:[1,1,1,1] row_mask:0xf bank_mask:0xf
    v_add_f32_dpp v28, v138, v28 quad_perm:[2,2,2,2] row_mask:0xf bank_mask:0xf
    v_add_f32_dpp v29, v142, v29 quad_perm:[2,2,2,2] row_mask:0xf bank_mask:0xf
    v_add_f32_dpp v30, v146, v30 quad_perm:[2,2,2,2] row_mask:0xf bank_mask:0xf
    v_add_f32_dpp v31, v150, v31 quad_perm:[2,2,2,2] row_mask:0xf bank_mask:0xf
    v_add_f32_dpp v28, v139, v28 quad_perm:[3,3,3,3] row_mask:0xf bank_mask:0xf
    v_add_f32_dpp v29, v143, v29 quad_perm:[3,3,3,3] row_mask:0xf bank_mask:0xf
    v_add_f32_dpp v30, v147, v30 quad_perm:[3,3,3,3] row_mask:0xf bank_mask:0xf
    v_add_f32_dpp v31, v151, v31 quad_perm:[3,3,3,3] row_mask:0xf bank_mask:0xf
    v_cndmask_b32 v28, v28, v29, s[74:75]
    v_cndmask_b32 v30, v30, v31, s[74:75]
    v_cndmask_b32 v15, v28, v30, s[76:77]
    s_mov_b32 s45, 0x3db504f3
    v_cvt_pk_bf16_f32 v28, v32, v33
    v_cvt_pk_bf16_f32 v29, v34, v35
    v_cvt_pk_bf16_f32 v30, v12, v13
    v_cvt_pk_bf16_f32 v31, v14, v15
    v_lshlrev_b32 v32, 16, v28
    v_and_b32 v33, 0xffff0000, v28
    v_mul_f32 v32, s45, v32
    v_mul_f32 v33, s45, v33
    v_cvt_pk_bf16_f32 v28, v32, v33
    v_lshlrev_b32 v34, 16, v29
    v_and_b32 v35, 0xffff0000, v29
    v_mul_f32 v34, s45, v34
    v_mul_f32 v35, s45, v35
    v_cvt_pk_bf16_f32 v29, v34, v35
    v_lshlrev_b32 v12, 16, v30
    v_and_b32 v13, 0xffff0000, v30
    v_mul_f32 v12, s45, v12
    v_mul_f32 v13, s45, v13
    v_cvt_pk_bf16_f32 v30, v12, v13
    v_lshlrev_b32 v14, 16, v31
    v_and_b32 v15, 0xffff0000, v31
    v_mul_f32 v14, s45, v14
    v_mul_f32 v15, s45, v15
    v_cvt_pk_bf16_f32 v31, v14, v15
    v_lshlrev_b32 v32, 16, v28
    v_and_b32 v33, 0xffff0000, v28
    v_lshlrev_b32 v34, 16, v29
    v_and_b32 v35, 0xffff0000, v29
    v_lshlrev_b32 v12, 16, v30
    v_and_b32 v13, 0xffff0000, v30
    v_lshlrev_b32 v14, 16, v31
    v_and_b32 v15, 0xffff0000, v31
    v_max3_f32 v16, v32, v33, v34
    v_max3_f32 v16, v16, v35, v12
    v_max3_f32 v16, v16, v13, v14
    v_max_f32 v16, v16, v15
    s_nop 1
    v_max_f32_dpp v16, v16, v16 row_ror:8 row_mask:0xf bank_mask:0xf
    s_nop 1
    v_max_f32_dpp v16, v16, v16 row_ror:4 row_mask:0xf bank_mask:0xf
    s_nop 1
    v_max_f32_dpp v16, v16, v16 row_ror:2 row_mask:0xf bank_mask:0xf
    s_nop 1
    v_max_f32_dpp v16, v16, v16 row_ror:1 row_mask:0xf bank_mask:0xf
    s_mov_b32 s45, 0x3fb8aa3b
    v_sub_f32 v32, v32, v16
    v_sub_f32 v33, v33, v16
    v_sub_f32 v34, v34, v16
    v_sub_f32 v35, v35, v16
    v_sub_f32 v12, v12, v16
    v_sub_f32 v13, v13, v16
    v_sub_f32 v14, v14, v16
    v_sub_f32 v15, v15, v16
    v_mul_f32 v32, s45, v32
    v_mul_f32 v33, s45, v33
    v_mul_f32 v34, s45, v34
    v_mul_f32 v35, s45, v35
    v_mul_f32 v12, s45, v12
    v_mul_f32 v13, s45, v13
    v_mul_f32 v14, s45, v14
    v_mul_f32 v15, s45, v15
    v_exp_f32 v32, v32
    v_exp_f32 v33, v33
    v_exp_f32 v34, v34
    v_exp_f32 v35, v35
    v_exp_f32 v12, v12
    v_exp_f32 v13, v13
    v_exp_f32 v14, v14
    v_exp_f32 v15, v15
    v_cvt_pk_bf16_f32 v28, v32, v33
    v_cvt_pk_bf16_f32 v29, v34, v35
    v_cvt_pk_bf16_f32 v30, v12, v13
    v_cvt_pk_bf16_f32 v31, v14, v15
    ds_write_b32 v37, v28 offset:1536
    ds_write_b32 v37, v29 offset:1600
    ds_write_b32 v37, v30 offset:1664
    ds_write_b32 v37, v31 offset:1728
    s_mov_b64 exec, 1
    ds_add_u32 v39, v7 offset:16
    s_mov_b64 exec, -1
    v_add_f32 v17, v32, v33
    v_add_f32 v17, v17, v34
    v_add_f32 v17, v17, v35
    v_add_f32 v17, v17, v12
    v_add_f32 v17, v17, v13
    v_add_f32 v17, v17, v14
    v_add_f32 v17, v17, v15
    s_nop 1
    v_add_f32_dpp v17, v17, v17 row_ror:8 row_mask:0xf bank_mask:0xf
    s_nop 1
    v_add_f32_dpp v17, v17, v17 row_ror:4 row_mask:0xf bank_mask:0xf
    s_nop 1
    v_add_f32_dpp v17, v17, v17 row_ror:2 row_mask:0xf bank_mask:0xf
    s_nop 1
    v_add_f32_dpp v17, v17, v17 row_ror:1 row_mask:0xf bank_mask:0xf
    ds_write_b64 v38, v[16:17] offset:12288
    s_mov_b64 exec, 1
    ds_add_u32 v6, v7 offset:56
    s_mov_b64 exec, -1
    s_endpgm
L_qwait:
L_w19:
    ds_read_b32 v5, v6 offset:0
    s_waitcnt lgkmcnt(0)
    v_readfirstlane_b32 s44, v5
    s_nop 0
    s_cmp_ge_u32 s44, 1
    s_cbranch_scc1 L_d20
    s_sleep 2
    s_sub_u32 s50, s50, 1
    s_cbranch_scc0 L_w19
    s_endpgm
L_d20:
L_qgather:
    v_lshlrev_b32 v1, 4, v0
    s_lshl_b32 s45, s27, 2
    s_add_u32 s45, s45, s29
    s_lshl_b32 s45, s45, 2
    s_add_u32 s45, s45, s26
    s_lshl_b32 s45, s45, 12
    s_add_u32 s45, s45, 4096
    v_and_b32 v5, 31, v0
    v_mul_u32_u24 v33, 6, v5
    v_lshrrev_b32 v5, 5, v0
    v_lshl_add_u32 v33, v5, 7, v33
    s_lshl_b32 s47, s26, 8
    v_add_u32 v33, s47, v33
    s_mov_b32 s79, 0
    s_mov_b32 exec_lo, 0x003fffff
    s_mov_b32 exec_hi, 0x003fffff
L_poll21:
    buffer_load_dwordx4 v[40:43], v1, s[40:43], s45 offen offset:0 sc1
    buffer_load_dwordx4 v[44:47], v1, s[40:43], s45 offen offset:1024 sc1
    buffer_load_dwordx4 v[48:51], v1, s[40:43], s45 offen offset:2048 sc1
    buffer_load_dwordx4 v[52:55], v1, s[40:43], s45 offen offset:3072 sc1
    s_waitcnt vmcnt(0)
    v_xor_b32 v43, s53, v43
    v_xor_b32 v47, s53, v47
    v_xor_b32 v51, s53, v51
    v_xor_b32 v55, s53, v55
    v_or3_b32 v5, v43, v47, v51
    v_or_b32 v5, v5, v55
    v_cmp_ne_u32 vcc, 0, v5
    s_cbranch_vccz L_qok
    s_mov_b64 s[74:75], vcc
    s_mov_b64 exec, -1
    s_lshl_b32 s44, s27, 2
    v_mov_b32 v34, s44
    s_add_u32 s79, s79, 1
    s_cmp_lt_u32 s79, 3
    s_cbranch_scc1 L_qagain
    s_mov_b64 exec, 1
    global_store_dword v34, v7, s[22:23] sc1
    s_mov_b64 exec, -1
    s_cmp_lg_u32 s26, 0
    s_cbranch_scc1 L_qagain
    s_mov_b32 exec_lo, 0x00ffffff
    s_mov_b32 exec_hi, 0x00ffffff
    buffer_store_dwordx4 v[120:123], v166, s[40:43], s48 offen sc1
    buffer_store_dwordx4 v[124:127], v166, s[40:43], s49 offen sc1
    s_mov_b64 exec, -1
L_qagain:
    s_mov_b64 exec, s[74:75]
    s_sleep 2
    s_sub_u32 s50, s50, 1
    s_cbranch_scc0 L_poll21
    s_endpgm
L_qok:
    s_mov_b32 exec_lo, 0x00200000
    s_mov_b32 exec_hi, 0x00200000
    v_xor_b32 v24, s73, v41
    v_xor_b32 v25, s73, v45
    v_xor_b32 v26, s73, v49
    v_xor_b32 v27, s73, v53
    v_or3_b32 v5, v24, v25, v26
    v_or_b32 v5, v5, v27
    v_cmp_ne_u32 vcc, 0, v5
    s_cbranch_vccz L_uniform
    s_mov_b64 exec, 1
    ds_add_u32 v6, v7 offset:4
    s_mov_b64 exec, -1
L_uniform:
    s_mov_b32 exec_lo, 0x003fffff
    s_mov_b32 exec_hi, 0x003fffff
    v_add_f32 v40, v40, v44
    v_add_f32 v48, v48, v52
    v_add_f32 v41, v41, v45
    v_add_f32 v49, v49, v53
    v_add_f32 v42, v42, v46
    v_add_f32 v50, v50, v54
    v_add_f32 v40, v40, v48
    v_add_f32 v41, v41, v49
    v_add_f32 v42, v42, v50
    v_cvt_pk_bf16_f32 v40, v40, v41
    v_cvt_pk_bf16_f32 v42, v42, v42
    ds_write_b16 v33, v40 offset:512
    s_mov_b32 exec_lo, 0x001fffff
    s_mov_b32 exec_hi, 0x001fffff
    ds_write_b16_d16_hi v33, v40 offset:514
    ds_write_b16 v33, v42 offset:516
    s_mov_b64 exec, 1
    ds_add_u32 v6, v7 offset:8
    s_mov_b64 exec, -1
    s_cmp_eq_u32 s26, 2
    s_cbranch_scc1 L_H2b
    s_cmp_eq_u32 s26, 3
    s_cbranch_scc1 L_H3b
    v_lshlrev_b32 v1, 13, v2
    v_lshl_add_u32 v1, v3, 4, v1
    s_cmp_eq_u32 s26, 1
    s_cbranch_scc1 L_H1b
    s_lshl_b32 s44, s27, 2
    v_mov_b32 v34, s44
    s_mov_b32 s45, 0
L_watch:
    ds_read_b32 v5, v6 offset:8
    s_waitcnt lgkmcnt(0)
    v_readfirstlane_b32 s44, v5
    s_nop 0
    s_cmp_ge_u32 s44, 4
    s_cbranch_scc1 L_wdone
    s_sleep 4
    s_add_u32 s45, s45, 1
    s_and_b32 s44, s45, 31
    s_cbranch_scc1 L_wnext
    global_load_dword v5, v34, s[22:23] sc1
    s_waitcnt vmcnt(0)
    v_readfirstlane_b32 s44, v5
    s_nop 0
    s_cmp_eq_u32 s44, 0
    s_cbranch_scc1 L_wnext
    s_mov_b32 exec_lo, 0x00ffffff
    s_mov_b32 exec_hi, 0x00ffffff
    buffer_store_dwordx4 v[120:123], v166, s[40:43], s48 offen sc1
    buffer_store_dwordx4 v[124:127], v166, s[40:43], s49 offen sc1
    s_mov_b64 exec, -1
L_wnext:
    s_sub_u32 s50, s50, 1
    s_cbranch_scc0 L_watch
    s_endpgm
L_wdone:
    ds_read_b32 v5, v6 offset:4
    s_waitcnt lgkmcnt(0)
    v_readfirstlane_b32 s79, v5
    s_nop 0
    s_cmp_eq_u32 s79, 0
    s_cbranch_scc1 L_proj
    s_mov_b32 exec_lo, 0x00ffffff
    s_mov_b32 exec_hi, 0x00ffffff
    buffer_store_dwordx4 v[120:123], v166, s[40:43], s48 offen sc1
    buffer_store_dwordx4 v[124:127], v166, s[40:43], s49 offen sc1
    s_mov_b64 exec, -1
    s_branch L_proj
L_H1b:
L_w22:
    ds_read_b32 v5, v6 offset:8
    s_waitcnt lgkmcnt(0)
    v_readfirstlane_b32 s44, v5
    s_nop 0
    s_cmp_ge_u32 s44, 4
    s_cbranch_scc1 L_d23
    s_sleep 2
    s_sub_u32 s50, s50, 1
    s_cbranch_scc0 L_w22
    s_endpgm
L_d23:
    ds_read_b32 v5, v6 offset:4
    s_waitcnt lgkmcnt(0)
    v_readfirstlane_b32 s79, v5
    s_nop 0
    s_cmp_eq_u32 s79, 0
    s_cbranch_scc1 L_h1u
    buffer_store_dwordx4 v[136:139], v166, s[40:43], s62 offen sc1
    buffer_store_dwordx4 v[140:143], v166, s[40:43], s63 offen sc1
L_h1u:
    s_waitcnt vmcnt(0)
    s_mov_b64 exec, 1
    ds_add_u32 v6, v7 offset:12
    s_mov_b64 exec, -1
L_proj:
    s_mov_b32 s32, s12
    s_mov_b32 s33, s13
    s_mov_b32 s34, 0x400000
    s_mov_b32 s35, 0x20000
    s_lshl_b32 s72, s70, 1
    s_add_u32 s72, s72, s26
    s_lshl_b32 s62, s72, 15
    s_lshl_b32 s46, s71, 8
    s_add_u32 s62, s62, s46
    s_add_u32 s63, s62, 4096
    v_bfe_u32 v4, v0, 2, 2
    v_and_b32 v5, 3, v0
    v_lshlrev_b32 v137, 10, v4
    v_lshl_add_u32 v137, v2, 7, v137
    s_lshl_b32 s64, s27, 12
    s_bfe_u32 s46, s70, 0x10002
    s_lshl_b32 s46, s46, 4
    s_add_u32 s64, s64, s46
    s_add_u32 s64, s64, 1277952
    v_lshlrev_b32 v100, 13, v4
    v_lshl_add_u32 v100, v2, 10, v100
    v_lshl_add_u32 v100, v5, 4, v100
    s_lshl_b32 s47, s27, 15
    s_and_b32 s48, s72, 15
    s_lshl_b32 s48, s48, 6
    s_add_u32 s47, s47, s48
    s_add_u32 s47, s47, 1310720
    s_add_u32 s48, s47, 4096
    s_lshl_b32 s45, s26, 8
    s_add_u32 s45, s45, 11776
    v_lshlrev_b32 v101, 6, v4
    v_lshl_add_u32 v101, v5, 4, v101
    v_lshl_add_u32 v101, v2, 2, v101
    v_add_u32 v101, s45, v101
    v_lshlrev_b32 v5, 6, v5
    v_lshl_add_u32 v5, v2, 4, v5
    v_add_u32 v5, s45, v5
    v_mov_b32 v4, 128
    v_cndmask_b32 v96, v4, v5, s[54:55]
    v_cndmask_b32 v97, v4, v5, s[56:57]
    v_cndmask_b32 v98, v4, v5, s[58:59]
    v_cndmask_b32 v99, v4, v5, s[60:61]
    v_lshlrev_b32 v138, 4, v0
    s_lshl_b32 s46, s71, 17
    s_lshl_b32 s45, s72, 10
    s_add_u32 s49, s45, s46
    s_add_u32 s49, s49, 1572864
    s_add_u32 s65, s49, 8192
    s_lshl_b32 s45, s26, 10
    v_add_u32 v103, s45, v138
    v_xor_b32 v136, 1024, v103
    v_mov_b32 v102, s78
    buffer_load_dwordx4 v[72:75], v138, s[40:43], s49 offen
L_w24:
    ds_read_b32 v5, v6 offset:40
    s_waitcnt lgkmcnt(0)
    v_readfirstlane_b32 s44, v5
    s_nop 0
    s_cmp_ge_u32 s44, 1
    s_cbranch_scc1 L_d25
    s_sleep 4
    s_sub_u32 s50, s50, 1
    s_cbranch_scc0 L_w24
    s_endpgm
L_d25:
L_w26:
    ds_read_b32 v5, v6 offset:52
    s_waitcnt lgkmcnt(0)
    v_readfirstlane_b32 s44, v5
    s_nop 0
    s_cmp_ge_u32 s44, 1
    s_cbranch_scc1 L_d27
    s_sleep 1
    s_sub_u32 s50, s50, 1
    s_cbranch_scc0 L_w26
    s_endpgm
L_d27:
    s_setprio 3
    buffer_load_dwordx4 v[40:43], v1, s[32:35], s62 offen offset:0 nt
    buffer_load_dwordx4 v[44:47], v1, s[32:35], s62 offen offset:1024 nt
    buffer_load_dwordx4 v[48:51], v1, s[32:35], s62 offen offset:2048 nt
    buffer_load_dwordx4 v[52:55], v1, s[32:35], s62 offen offset:3072 nt
    buffer_load_dwordx4 v[56:59], v1, s[32:35], s63 offen offset:0 nt
    buffer_load_dwordx4 v[60:63], v1, s[32:35], s63 offen offset:1024 nt
    buffer_load_dwordx4 v[64:67], v1, s[32:35], s63 offen offset:2048 nt
    buffer_load_dwordx4 v[68:71], v1, s[32:35], s63 offen offset:3072 nt
    buffer_load_dwordx4 v[144:147], v137, s[40:43], s64 offen offset:0 sc1
    buffer_load_dwordx4 v[148:151], v137, s[40:43], s64 offen offset:512 sc1
    s_mov_b64 exec, 1
    ds_add_u32 v6, v7 offset:72
    s_mov_b64 exec, -1
    v_mov_b32 v32, 0
    v_mov_b32 v33, 0
    v_mov_b32 v34, 0
    v_mov_b32 v35, 0
    v_mov_b32 v36, 0
    v_mov_b32 v37, 0
    v_mov_b32 v38, 0
    v_mov_b32 v39, 0
    s_waitcnt vmcnt(8)
    v_perm_b32 v104, v44, v40, s51
    v_perm_b32 v108, v44, v40, s52
    v_perm_b32 v112, v45, v41, s51
    v_perm_b32 v116, v45, v41, s52
    v_perm_b32 v120, v46, v42, s51
    v_perm_b32 v124, v46, v42, s52
    v_perm_b32 v128, v47, v43, s51
    v_perm_b32 v132, v47, v43, s52
    s_waitcnt vmcnt(6)
    v_perm_b32 v105, v52, v48, s51
    v_perm_b32 v109, v52, v48, s52
    v_perm_b32 v113, v53, v49, s51
    v_perm_b32 v117, v53, v49, s52
    v_perm_b32 v121, v54, v50, s51
    v_perm_b32 v125, v54, v50, s52
    v_perm_b32 v129, v55, v51, s51
    v_perm_b32 v133, v55, v51, s52
    s_waitcnt vmcnt(4)
    v_perm_b32 v106, v60, v56, s51
    v_perm_b32 v110, v60, v56, s52
    v_perm_b32 v114, v61, v57, s51
    v_perm_b32 v118, v61, v57, s52
    v_perm_b32 v122, v62, v58, s51
    v_perm_b32 v126, v62, v58, s52
    v_perm_b32 v130, v63, v59, s51
    v_perm_b32 v134, v63, v59, s52
    s_waitcnt vmcnt(2)
    v_perm_b32 v107, v68, v64, s51
    v_perm_b32 v111, v68, v64, s52
    v_perm_b32 v115, v69, v65, s51
    v_perm_b32 v119, v69, v65, s52
    v_perm_b32 v123, v70, v66, s51
    v_perm_b32 v127, v70, v66, s52
    v_perm_b32 v131, v71, v67, s51
    v_perm_b32 v135, v71, v67, s52
    s_branch L_stchk
L_poll28:
    buffer_load_dwordx4 v[144:147], v137, s[40:43], s64 offen offset:0 sc1
    buffer_load_dwordx4 v[148:151], v137, s[40:43], s64 offen offset:512 sc1
L_stchk:
    s_waitcnt vmcnt(0)
    v_xor_b32 v144, s96, v144
    v_xor_b32 v145, s97, v145
    v_xor_b32 v146, s98, v146
    v_xor_b32 v147, s99, v147
    v_xor_b32 v148, s96, v148
    v_xor_b32 v149, s97, v149
    v_xor_b32 v150, s98, v150
    v_xor_b32 v151, s99, v151
    v_or3_b32 v5, v144, v145, v146
    v_or3_b32 v5, v5, v147, v148
    v_or3_b32 v5, v5, v149, v150
    v_or_b32 v5, v5, v151
    v_and_b32 v5, 0xff, v5
    v_cmp_ne_u32 vcc, 0, v5
    s_nop 0
    s_mov_b64 exec, vcc
    s_cbranch_vccz L_d29
    s_sleep 4
    s_sub_u32 s50, s50, 1
    s_cbranch_scc0 L_poll28
    s_endpgm
L_d29:
    s_mov_b64 exec, -1
    buffer_load_dwordx4 v[72:75], v100, s[40:43], s47 offen sc1
    buffer_load_dwordx4 v[76:79], v100, s[40:43], s48 offen sc1
    s_bitcmp1_b32 s70, 1
    s_cbranch_scc0 L_evenh
    v_mov_b32 v144, v146
    v_mov_b32 v145, v147
    v_mov_b32 v148, v150
    v_mov_b32 v149, v151
L_evenh:
    v_max_f32 v146, v144, v148
    v_mov_b32 v147, v146
    s_nop 1
    v_permlane16_swap_b32 v146, v147
    v_max_f32 v146, v146, v147
    v_mov_b32 v147, v146
    s_nop 1
    v_permlane32_swap_b32 v146, v147
    v_max_f32 v146, v146, v147
    s_mov_b32 s44, 0x3fb8aa3b
    v_sub_f32 v144, v144, v146
    v_sub_f32 v148, v148, v146
    v_mul_f32 v144, s44, v144
    v_mul_f32 v148, s44, v148
    v_exp_f32 v144, v144
    v_exp_f32 v148, v148
    v_mul_f32 v146, v144, v145
    v_fmac_f32 v146, v148, v149
    v_mov_b32 v147, v146
    s_nop 1
    v_permlane16_swap_b32 v146, v147
    v_add_f32 v146, v146, v147
    v_mov_b32 v147, v146
    s_nop 1
    v_permlane32_swap_b32 v146, v147
    v_add_f32 v146, v146, v147
    v_rcp_f32 v146, v146
    s_nop 0
    v_mul_f32 v140, v144, v146
    v_mul_f32 v142, v148, v146
    v_mov_b32 v141, v140
    v_mov_b32 v143, v142
    s_branch L_opchk
L_poll30:
    buffer_load_dwordx4 v[72:75], v100, s[40:43], s47 offen sc1
    buffer_load_dwordx4 v[76:79], v100, s[40:43], s48 offen sc1
L_opchk:
    s_waitcnt vmcnt(0)
    v_max3_u32 v4, v72, v73, v74
    v_max3_u32 v5, v75, v76, v77
    v_max3_u32 v4, v4, v78, v79
    v_max_u32 v4, v4, v5
    v_cmp_eq_u32 vcc, -1, v4
    s_nop 0
    s_mov_b64 exec, vcc
    s_cbranch_vccz L_d31
    s_sub_u32 s50, s50, 1
    s_cbranch_scc0 L_poll30
    s_endpgm
L_d31:
    s_mov_b64 exec, -1
    v_lshlrev_b32 v80, 16, v72
    v_and_b32 v81, 0xffff0000, v72
    v_lshlrev_b32 v82, 16, v73
    v_and_b32 v83, 0xffff0000, v73
    v_lshlrev_b32 v84, 16, v74
    v_and_b32 v85, 0xffff0000, v74
    v_lshlrev_b32 v86, 16, v75
    v_and_b32 v87, 0xffff0000, v75
    v_lshlrev_b32 v88, 16, v76
    v_and_b32 v89, 0xffff0000, v76
    v_pk_mul_f32 v[80:81], v[80:81], v[140:141]
    v_lshlrev_b32 v90, 16, v77
    v_and_b32 v91, 0xffff0000, v77
    v_pk_mul_f32 v[82:83], v[82:83], v[140:141]
    v_lshlrev_b32 v92, 16, v78
    v_and_b32 v93, 0xffff0000, v78
    v_pk_mul_f32 v[84:85], v[84:85], v[140:141]
    v_lshlrev_b32 v94, 16, v79
    v_and_b32 v95, 0xffff0000, v79
    v_pk_mul_f32 v[86:87], v[86:87], v[140:141]
    v_pk_fma_f32 v[80:81], v[88:89], v[142:143], v[80:81]
    v_pk_fma_f32 v[82:83], v[90:91], v[142:143], v[82:83]
    v_pk_fma_f32 v[84:85], v[92:93], v[142:143], v[84:85]
    v_pk_fma_f32 v[86:87], v[94:95], v[142:143], v[86:87]
    s_nop 0
    v_permlane32_swap_b32 v80, v84
    v_permlane32_swap_b32 v81, v85
    v_permlane32_swap_b32 v82, v86
    v_permlane32_swap_b32 v83, v87
    v_pk_add_f32 v[80:81], v[80:81], v[84:85]
    v_pk_add_f32 v[82:83], v[82:83], v[86:87]
    s_nop 1
    v_permlane16_swap_b32 v80, v82
    v_permlane16_swap_b32 v81, v83
    v_pk_add_f32 v[80:81], v[80:81], v[82:83]
    v_cvt_pk_bf16_f32 v5, v80, v81
    ds_write_b32 v101, v5
    ds_read_b128 v[8:11], v96
    ds_read_b128 v[12:15], v97
    ds_read_b128 v[16:19], v98
    ds_read_b128 v[20:23], v99
    s_cmp_eq_u32 s26, 1
    s_cbranch_scc1 L_keep1
    s_waitcnt lgkmcnt(3)
    v_mfma_f32_16x16x32_bf16 v[36:39], v[8:11], v[120:123], v[36:39]
    s_waitcnt lgkmcnt(2)
    v_mfma_f32_16x16x32_bf16 v[36:39], v[12:15], v[124:127], v[36:39]
    s_waitcnt lgkmcnt(1)
    v_mfma_f32_16x16x32_bf16 v[36:39], v[16:19], v[128:131], v[36:39]
    s_waitcnt lgkmcnt(0)
    v_mfma_f32_16x16x32_bf16 v[36:39], v[20:23], v[132:135], v[36:39]
    v_mfma_f32_16x16x32_bf16 v[32:35], v[8:11], v[104:107], v[32:35]
    v_mfma_f32_16x16x32_bf16 v[32:35], v[12:15], v[108:111], v[32:35]
    v_mfma_f32_16x16x32_bf16 v[32:35], v[16:19], v[112:115], v[32:35]
    v_mfma_f32_16x16x32_bf16 v[32:35], v[20:23], v[116:119], v[32:35]
    s_nop 3
    v_min_u32 v36, 0xfffffffe, v36
    v_min_u32 v37, 0xfffffffe, v37
    v_min_u32 v38, 0xfffffffe, v38
    v_min_u32 v39, 0xfffffffe, v39
    ds_write_b128 v136, v[36:39] offset:12544
L_xp32:
    ds_read_b128 v[72:75], v103 offset:12544
    ds_read_b128 v[76:79], v103 offset:14592
    s_waitcnt lgkmcnt(0)
    v_max3_u32 v4, v72, v73, v74
    v_max3_u32 v5, v75, v76, v77
    v_max3_u32 v4, v4, v78, v79
    v_max_u32 v4, v4, v5
    v_cmp_eq_u32 vcc, -1, v4
    s_cbranch_vccz L_d33
    s_sub_u32 s50, s50, 1
    s_cbranch_scc0 L_xp32
    s_endpgm
L_d33:
    v_pk_add_f32 v[72:73], v[76:77], v[72:73]
    v_pk_add_f32 v[74:75], v[78:79], v[74:75]
    v_pk_add_f32 v[72:73], v[32:33], v[72:73]
    v_pk_add_f32 v[74:75], v[34:35], v[74:75]
    v_and_or_b32 v72, v72, v102, s96
    v_and_or_b32 v73, v73, v102, s97
    v_and_or_b32 v74, v74, v102, s98
    v_and_or_b32 v75, v75, v102, s99
    buffer_store_dwordx4 v[72:75], v138, s[40:43], s49 offen sc1
    s_mov_b64 exec, 1
    ds_add_u32 v6, v7 offset:48
    s_mov_b64 exec, -1
    s_endpgm
L_keep1:
    s_waitcnt lgkmcnt(3)
    v_mfma_f32_16x16x32_bf16 v[32:35], v[8:11], v[104:107], v[32:35]
    s_waitcnt lgkmcnt(2)
    v_mfma_f32_16x16x32_bf16 v[32:35], v[12:15], v[108:111], v[32:35]
    s_waitcnt lgkmcnt(1)
    v_mfma_f32_16x16x32_bf16 v[32:35], v[16:19], v[112:115], v[32:35]
    s_waitcnt lgkmcnt(0)
    v_mfma_f32_16x16x32_bf16 v[32:35], v[20:23], v[116:119], v[32:35]
    v_mfma_f32_16x16x32_bf16 v[36:39], v[8:11], v[120:123], v[36:39]
    v_mfma_f32_16x16x32_bf16 v[36:39], v[12:15], v[124:127], v[36:39]
    v_mfma_f32_16x16x32_bf16 v[36:39], v[16:19], v[128:131], v[36:39]
    v_mfma_f32_16x16x32_bf16 v[36:39], v[20:23], v[132:135], v[36:39]
    s_nop 3
    v_min_u32 v32, 0xfffffffe, v32
    v_min_u32 v33, 0xfffffffe, v33
    v_min_u32 v34, 0xfffffffe, v34
    v_min_u32 v35, 0xfffffffe, v35
    ds_write_b128 v136, v[32:35] offset:12544
L_xp34:
    ds_read_b128 v[72:75], v103 offset:12544
    ds_read_b128 v[76:79], v103 offset:14592
    s_waitcnt lgkmcnt(0)
    v_max3_u32 v4, v72, v73, v74
    v_max3_u32 v5, v75, v76, v77
    v_max3_u32 v4, v4, v78, v79
    v_max_u32 v4, v4, v5
    v_cmp_eq_u32 vcc, -1, v4
    s_cbranch_vccz L_d35
    s_sub_u32 s50, s50, 1
    s_cbranch_scc0 L_xp34
    s_endpgm
L_d35:
    v_pk_add_f32 v[72:73], v[76:77], v[72:73]
    v_pk_add_f32 v[74:75], v[78:79], v[74:75]
    v_pk_add_f32 v[72:73], v[36:37], v[72:73]
    v_pk_add_f32 v[74:75], v[38:39], v[74:75]
    v_and_or_b32 v72, v72, v102, s96
    v_and_or_b32 v73, v73, v102, s97
    v_and_or_b32 v74, v74, v102, s98
    v_and_or_b32 v75, v75, v102, s99
    buffer_store_dwordx4 v[72:75], v138, s[40:43], s49 offen sc1
    s_mov_b64 exec, 1
    ds_add_u32 v6, v7 offset:48
    s_mov_b64 exec, -1
    s_endpgm
L_H3b:
    v_and_b32 v4, 7, v0
    v_lshlrev_b32 v1, 4, v4
    v_lshlrev_b32 v4, 3, v4
    s_lshl_b32 s45, s27, 5
    s_add_u32 s45, s45, s28
    s_lshl_b32 s45, s45, 7
    s_add_u32 s45, s45, 1277952
L_w36:
    ds_read_b32 v5, v6 offset:56
    s_waitcnt lgkmcnt(0)
    v_readfirstlane_b32 s44, v5
    s_nop 0
    s_cmp_ge_u32 s44, 4
    s_cbranch_scc1 L_d37
    s_sleep 2
    s_sub_u32 s50, s50, 1
    s_cbranch_scc0 L_w36
    s_endpgm
L_d37:
    ds_read_b32 v5, v6 offset:4
    s_waitcnt lgkmcnt(0)
    v_readfirstlane_b32 s79, v5
L_w38:
    ds_read_b32 v5, v6 offset:12
    s_waitcnt lgkmcnt(0)
    v_readfirstlane_b32 s44, v5
    s_nop 0
    s_cmp_ge_u32 s44, 1
    s_cbranch_scc1 L_d39
    s_sleep 2
    s_sub_u32 s50, s50, 1
    s_cbranch_scc0 L_w38
    s_endpgm
L_d39:
    ds_read_b128 v[8:11], v1 offset:12288
    s_waitcnt lgkmcnt(0)
    v_mov_b32 v12, v8
    v_mov_b32 v14, v10
    s_nop 0
    v_max_f32_dpp v12, v12, v12 quad_perm:[2,3,0,1] row_mask:0xf bank_mask:0xf
    s_nop 1
    v_max_f32_dpp v12, v12, v12 row_ror:4 row_mask:0xf bank_mask:0xf
    v_max_f32_dpp v14, v14, v14 quad_perm:[2,3,0,1] row_mask:0xf bank_mask:0xf
    s_nop 1
    v_max_f32_dpp v14, v14, v14 row_ror:4 row_mask:0xf bank_mask:0xf
    s_mov_b32 s44, 0x3fb8aa3b
    v_sub_f32 v8, v8, v12
    v_sub_f32 v10, v10, v14
    v_mul_f32 v8, s44, v8
    v_mul_f32 v10, s44, v10
    v_exp_f32 v16, v8
    v_exp_f32 v17, v10
    v_mul_f32 v13, v16, v9
    v_mul_f32 v15, v17, v11
    ds_write_b64 v4, v[16:17] offset:384
    v_add_f32_dpp v13, v13, v13 quad_perm:[2,3,0,1] row_mask:0xf bank_mask:0xf
    s_nop 1
    v_add_f32_dpp v13, v13, v13 row_ror:4 row_mask:0xf bank_mask:0xf
    v_add_f32_dpp v15, v15, v15 quad_perm:[2,3,0,1] row_mask:0xf bank_mask:0xf
    s_nop 1
    v_add_f32_dpp v15, v15, v15 row_ror:4 row_mask:0xf bank_mask:0xf
    v_and_b32 v12, s78, v12
    v_and_b32 v13, s78, v13
    v_and_b32 v14, s78, v14
    v_and_b32 v15, s78, v15
    v_or_b32 v12, s96, v12
    v_or_b32 v13, s97, v13
    v_or_b32 v14, s98, v14
    v_or_b32 v15, s99, v15
    s_mov_b64 exec, 3
    s_cmp_lg_u32 s79, 0
    s_cbranch_scc1 L_s40
    buffer_store_dwordx4 v[12:15], v1, s[40:43], s45 offen
    s_branch L_d41
L_s40:
    buffer_store_dwordx4 v[12:15], v1, s[40:43], s45 offen sc1
L_d41:
    s_mov_b64 exec, 1
    ds_add_u32 v6, v7 offset:40
    s_mov_b64 exec, -1
    s_endpgm
L_H2b:
    v_lshlrev_b32 v1, 13, v2
    v_lshl_add_u32 v1, v3, 4, v1
    s_mov_b32 s32, s18
    s_mov_b32 s33, s19
    s_mov_b32 s34, 0x1c0000
    s_mov_b32 s35, 0x20000
    s_cmp_lg_u32 s27, 0
    s_cbranch_scc1 L_mlp
    v_mov_b32 v32, 0
    v_mov_b32 v33, 0
    v_mov_b32 v34, 0
    v_mov_b32 v35, 0
    v_lshlrev_b32 v4, 4, v0
    ds_write_b128 v4, v[32:35] offset:14592
    ds_write_b128 v4, v[32:35] offset:15616
    s_branch L_final
L_mlp:
    s_mov_b32 s47, 4
    v_mov_b32 v5, v1
    s_and_b32 s48, s70, 7
    s_lshl_b32 s48, s48, 5
    s_sub_u32 s45, s27, 1
    s_and_b32 s45, s45, 7
    s_lshl_b32 s45, s45, 2
    s_lshl_b32 s45, s45, 6
    s_add_u32 s45, s45, s48
    s_lshl_b32 s45, s45, 10
    s_lshl_b32 s46, s71, 8
    s_add_u32 s45, s45, s46
    s_add_u32 s46, s45, 4096
    s_mov_b32 s64, s18
    s_mov_b32 s65, s19
    s_mov_b32 s66, 0x1c0000
    s_mov_b32 s67, 0x20000
    s_mov_b32 s68, s45
    s_mov_b32 s69, s46
    v_mov_b32 v138, v1
    v_mov_b32 v139, v5
    v_lshrrev_b32 v4, 3, v0
    v_lshlrev_b32 v4, 10, v4
    v_and_b32 v33, 7, v0
    s_lshl_b32 s47, s47, 1
    s_sub_u32 s46, s47, 1
    v_min_u32 v5, s46, v33
    v_lshlrev_b32 v5, 2, v5
    v_add_u32 v5, s48, v5
    v_lshrrev_b32 v34, 6, v5
    v_lshl_add_u32 v4, v34, 13, v4
    v_and_b32 v5, 63, v5
    v_lshl_add_u32 v4, v5, 2, v4
    s_lshl_b32 s45, s27, 15
    s_add_u32 s45, s45, 802816
L_poll42:
    buffer_load_dwordx4 v[88:91], v4, s[40:43], s45 offen offset:0 sc1
    buffer_load_dwordx4 v[92:95], v4, s[40:43], s45 offen offset:256 sc1
    buffer_load_dwordx4 v[96:99], v4, s[40:43], s45 offen offset:512 sc1
    buffer_load_dwordx4 v[100:103], v4, s[40:43], s45 offen offset:768 sc1
    s_waitcnt vmcnt(0)
    v_xor_b32 v88, s96, v88
    v_xor_b32 v89, s97, v89
    v_xor_b32 v90, s98, v90
    v_xor_b32 v91, s99, v91
    v_xor_b32 v92, s96, v92
    v_xor_b32 v93, s97, v93
    v_xor_b32 v94, s98, v94
    v_xor_b32 v95, s99, v95
    v_xor_b32 v96, s96, v96
    v_xor_b32 v97, s97, v97
    v_xor_b32 v98, s98, v98
    v_xor_b32 v99, s99, v99
    v_xor_b32 v100, s96, v100
    v_xor_b32 v101, s97, v101
    v_xor_b32 v102, s98, v102
    v_xor_b32 v103, s99, v103
    v_or3_b32 v24, v88, v89, v90
    v_or3_b32 v25, v96, v97, v98
    v_or3_b32 v24, v24, v91, v92
    v_or3_b32 v25, v25, v99, v100
    v_or3_b32 v24, v24, v93, v94
    v_or3_b32 v25, v25, v101, v102
    v_or_b32 v24, v24, v95
    v_or_b32 v25, v25, v103
    v_or_b32 v24, v24, v25
    v_and_b32 v24, 0xff, v24
    v_cmp_ne_u32 vcc, 0, v24
    s_nop 0
    s_mov_b64 exec, vcc
    s_cbranch_vccz L_d43
    s_sleep 2
    s_sub_u32 s50, s50, 1
    s_cbranch_scc0 L_poll42
    s_endpgm
L_d43:
    s_mov_b64 exec, -1
    v_mov_b32 v72, v88
    v_mov_b32 v73, v89
    v_mov_b32 v74, v90
    v_mov_b32 v75, v91
    v_mov_b32 v80, v92
    v_mov_b32 v81, v93
    v_mov_b32 v82, v94
    v_mov_b32 v83, v95
    v_mov_b32 v88, v96
    v_mov_b32 v89, v97
    v_mov_b32 v90, v98
    v_mov_b32 v91, v99
    v_mov_b32 v96, v100
    v_mov_b32 v97, v101
    v_mov_b32 v98, v102
    v_mov_b32 v99, v103
    v_permlane32_swap_b32 v72, v88
    v_permlane32_swap_b32 v73, v89
    v_permlane32_swap_b32 v74, v90
    v_permlane32_swap_b32 v75, v91
    v_permlane32_swap_b32 v80, v96
    v_permlane32_swap_b32 v81, v97
    v_permlane32_swap_b32 v82, v98
    v_permlane32_swap_b32 v83, v99
    v_pk_add_f32 v[72:73], v[72:73], v[88:89]
    v_pk_add_f32 v[74:75], v[74:75], v[90:91]
    v_pk_add_f32 v[80:81], v[80:81], v[96:97]
    v_pk_add_f32 v[82:83], v[82:83], v[98:99]
    s_nop 0
    v_permlane16_swap_b32 v72, v80
    v_permlane16_swap_b32 v73, v81
    v_permlane16_swap_b32 v74, v82
    v_permlane16_swap_b32 v75, v83
    v_pk_add_f32 v[72:73], v[72:73], v[80:81]
    v_pk_add_f32 v[74:75], v[74:75], v[82:83]
    s_nop 0
    v_add_f32_dpp v72, v72, v72 row_ror:8 row_mask:0xf bank_mask:0xf
    v_add_f32_dpp v73, v73, v73 row_ror:8 row_mask:0xf bank_mask:0xf
    v_add_f32_dpp v74, v74, v74 row_ror:8 row_mask:0xf bank_mask:0xf
    v_add_f32_dpp v75, v75, v75 row_ror:8 row_mask:0xf bank_mask:0xf
    v_cvt_pk_bf16_f32 v80, v72, v73
    v_cvt_pk_bf16_f32 v81, v74, v75
    v_lshlrev_b32 v72, 16, v80
    v_and_b32 v73, 0xffff0000, v80
    v_lshlrev_b32 v74, 16, v81
    v_and_b32 v75, 0xffff0000, v81
    s_mov_b32 s44, 0xbfb8aa3b
    v_mul_f32 v80, s44, v72
    v_mul_f32 v81, s44, v73
    v_mul_f32 v82, s44, v74
    v_mul_f32 v83, s44, v75
    v_exp_f32 v80, v80
    v_exp_f32 v81, v81
    v_exp_f32 v82, v82
    v_exp_f32 v83, v83
    v_add_f32 v80, 1.0, v80
    v_add_f32 v81, 1.0, v81
    v_add_f32 v82, 1.0, v82
    v_add_f32 v83, 1.0, v83
    v_rcp_f32 v80, v80
    v_rcp_f32 v81, v81
    v_rcp_f32 v82, v82
    v_rcp_f32 v83, v83
    v_mul_f32 v72, v72, v80
    v_mul_f32 v73, v73, v81
    v_mul_f32 v74, v74, v82
    v_mul_f32 v75, v75, v83
    v_cvt_pk_bf16_f32 v80, v72, v73
    v_cvt_pk_bf16_f32 v81, v74, v75
    v_cmp_le_u32 vcc, s47, v33
    s_nop 1
    v_cndmask_b32 v80, v80, 0, vcc
    v_cndmask_b32 v81, v81, 0, vcc
    v_lshlrev_b32 v4, 6, v2
    v_lshl_add_u32 v4, v33, 3, v4
    ds_write_b64 v4, v[80:81] offset:16640
    v_and_b32 v5, 3, v0
    v_lshlrev_b32 v5, 6, v5
    v_lshl_add_u32 v5, v2, 4, v5
    v_add_u32 v5, 16640, v5
    v_mov_b32 v4, 128
    v_cndmask_b32 v72, v4, v5, s[54:55]
    v_cndmask_b32 v73, v4, v5, s[56:57]
    v_cndmask_b32 v74, v4, v5, s[58:59]
    v_cndmask_b32 v75, v4, v5, s[60:61]
    ds_read_b128 v[8:11], v72
    ds_read_b128 v[12:15], v73
    ds_read_b128 v[16:19], v74
    ds_read_b128 v[20:23], v75
    s_waitcnt lgkmcnt(0)
L_final:
    s_lshr_b32 s44, s27, 1
    s_lshr_b32 s45, s28, 4
    s_bfe_u32 s46, s28, 0x20002
    s_lshl_b32 s46, s46, 4
    s_and_b32 s47, s27, 1
    s_lshl_b32 s47, s47, 3
    s_add_u32 s46, s46, s47
    s_lshl_b32 s47, s71, 1
    s_add_u32 s46, s46, s47
    v_and_b32 v4, 1, v0
    v_add_u32 v4, s46, v4
    v_lshrrev_b32 v5, 1, v0
    v_lshlrev_b32 v5, 11, v5
    v_lshl_add_u32 v1, v4, 4, v5
    s_lshl_b32 s46, s44, 17
    s_lshl_b32 s47, s45, 10
    s_add_u32 s46, s46, s47
    s_add_u32 s49, s46, 1572864
    s_add_u32 s54, s49, 65536
    v_and_b32 v5, 15, v4
    v_lshlrev_b32 v5, 3, v5
    v_lshrrev_b32 v4, 4, v4
    v_add_u32 v4, v4, v5
    s_lshl_b32 s44, s44, 7
    s_lshl_b32 s45, s45, 2
    s_add_u32 s44, s44, s45
    v_add_u32 v4, s44, v4
    v_lshlrev_b32 v4, 1, v4
    v_lshl_add_u32 v30, v2, 10, v4
    s_mov_b32 s32, s4
    s_mov_b32 s33, s5
    s_mov_b32 s34, 0x1000
    s_mov_b32 s35, 0x20000
    s_mov_b32 s36, s20
    s_mov_b32 s37, s21
    s_mov_b32 s38, 0x1000
    s_mov_b32 s39, 0x20000
    buffer_load_ushort v31, v30, s[32:35], 0 offen
    v_mov_b32 v29, s53
    s_setprio 3
    s_cmp_eq_u32 s27, 0
    s_cbranch_scc1 L_now2
L_w44:
    ds_read_b32 v5, v6 offset:72
    s_waitcnt lgkmcnt(0)
    v_readfirstlane_b32 s44, v5
    s_nop 0
    s_cmp_ge_u32 s44, 2
    s_cbranch_scc1 L_d45
    s_sleep 1
    s_sub_u32 s50, s50, 1
    s_cbranch_scc0 L_w44
    s_endpgm
L_d45:
    buffer_load_dwordx4 v[104:107], v138, s[64:67], s68 offen offset:0 nt
    buffer_load_dwordx4 v[108:111], v138, s[64:67], s68 offen offset:1024 nt
    buffer_load_dwordx4 v[112:115], v138, s[64:67], s68 offen offset:2048 nt
    buffer_load_dwordx4 v[116:119], v138, s[64:67], s68 offen offset:3072 nt
    buffer_load_dwordx4 v[120:123], v139, s[64:67], s69 offen offset:0 nt
    buffer_load_dwordx4 v[124:127], v139, s[64:67], s69 offen offset:1024 nt
    buffer_load_dwordx4 v[128:131], v139, s[64:67], s69 offen offset:2048 nt
    buffer_load_dwordx4 v[132:135], v139, s[64:67], s69 offen offset:3072 nt
    s_waitcnt vmcnt(6)
    v_perm_b32 v72, v108, v104, s51
    v_perm_b32 v76, v108, v104, s52
    v_perm_b32 v80, v109, v105, s51
    v_perm_b32 v84, v109, v105, s52
    v_perm_b32 v88, v110, v106, s51
    v_perm_b32 v92, v110, v106, s52
    v_perm_b32 v96, v111, v107, s51
    v_perm_b32 v100, v111, v107, s52
    s_waitcnt vmcnt(4)
    v_perm_b32 v73, v116, v112, s51
    v_perm_b32 v77, v116, v112, s52
    v_perm_b32 v81, v117, v113, s51
    v_perm_b32 v85, v117, v113, s52
    v_perm_b32 v89, v118, v114, s51
    v_perm_b32 v93, v118, v114, s52
    v_perm_b32 v97, v119, v115, s51
    v_perm_b32 v101, v119, v115, s52
    s_waitcnt vmcnt(2)
    v_perm_b32 v74, v124, v120, s51
    v_perm_b32 v78, v124, v120, s52
    v_perm_b32 v82, v125, v121, s51
    v_perm_b32 v86, v125, v121, s52
    v_perm_b32 v90, v126, v122, s51
    v_perm_b32 v94, v126, v122, s52
    v_perm_b32 v98, v127, v123, s51
    v_perm_b32 v102, v127, v123, s52
    s_waitcnt vmcnt(0)
    v_perm_b32 v75, v132, v128, s51
    v_perm_b32 v79, v132, v128, s52
    v_perm_b32 v83, v133, v129, s51
    v_perm_b32 v87, v133, v129, s52
    v_perm_b32 v91, v134, v130, s51
    v_perm_b32 v95, v134, v130, s52
    v_perm_b32 v99, v135, v131, s51
    v_perm_b32 v103, v135, v131, s52
    v_mfma_f32_16x16x32_bf16 v[32:35], v[8:11], v[72:75], 0
    v_mfma_f32_16x16x32_bf16 v[36:39], v[8:11], v[88:91], 0
    v_mfma_f32_16x16x32_bf16 v[32:35], v[12:15], v[76:79], v[32:35]
    v_mfma_f32_16x16x32_bf16 v[36:39], v[12:15], v[92:95], v[36:39]
    v_mfma_f32_16x16x32_bf16 v[32:35], v[16:19], v[80:83], v[32:35]
    v_mfma_f32_16x16x32_bf16 v[36:39], v[16:19], v[96:99], v[36:39]
    v_mfma_f32_16x16x32_bf16 v[32:35], v[20:23], v[84:87], v[32:35]
    v_mfma_f32_16x16x32_bf16 v[36:39], v[20:23], v[100:103], v[36:39]
    s_nop 6
    v_min_u32 v32, 0xfffffffe, v32
    v_min_u32 v33, 0xfffffffe, v33
    v_min_u32 v34, 0xfffffffe, v34
    v_min_u32 v35, 0xfffffffe, v35
    v_min_u32 v36, 0xfffffffe, v36
    v_min_u32 v37, 0xfffffffe, v37
    v_min_u32 v38, 0xfffffffe, v38
    v_min_u32 v39, 0xfffffffe, v39
    v_lshlrev_b32 v4, 4, v0
    ds_write_b128 v4, v[32:35] offset:14592
    ds_write_b128 v4, v[36:39] offset:15616
L_now2:
    s_waitcnt vmcnt(0)
    v_lshlrev_b32 v31, 16, v31
L_w46:
    ds_read_b32 v5, v6 offset:48
    s_waitcnt lgkmcnt(0)
    v_readfirstlane_b32 s44, v5
    s_nop 0
    s_cmp_ge_u32 s44, 2
    s_cbranch_scc1 L_d47
    s_sleep 1
    s_sub_u32 s50, s50, 1
    s_cbranch_scc0 L_w46
    s_endpgm
L_d47:
    buffer_load_dwordx4 v[56:59], v1, s[40:43], s49 offen sc1
    buffer_load_dwordx4 v[60:63], v1, s[40:43], s54 offen sc1
    buffer_load_dwordx4 v[64:67], v1, s[40:43], s49 offen sc1
    buffer_load_dwordx4 v[68:71], v1, s[40:43], s54 offen sc1
L_poll48:
    s_waitcnt vmcnt(2)
    v_xor_b32 v56, s96, v56
    v_xor_b32 v57, s97, v57
    v_xor_b32 v58, s98, v58
    v_xor_b32 v59, s99, v59
    v_xor_b32 v60, s96, v60
    v_xor_b32 v61, s97, v61
    v_xor_b32 v62, s98, v62
    v_xor_b32 v63, s99, v63
    v_or3_b32 v8, v56, v57, v58
    v_or3_b32 v8, v8, v59, v60
    v_or3_b32 v8, v8, v61, v62
    v_or_b32 v8, v8, v63
    v_and_b32 v8, 0xff, v8
    v_cmp_ne_u32 vcc, 0, v8
    s_nop 0
    s_andn2_b64 exec, exec, vcc
    v_mov_b32 v40, v56
    v_mov_b32 v41, v57
    v_mov_b32 v42, v58
    v_mov_b32 v43, v59
    v_mov_b32 v44, v60
    v_mov_b32 v45, v61
    v_mov_b32 v46, v62
    v_mov_b32 v47, v63
    s_mov_b64 exec, vcc
    s_cbranch_vccz L_d49
    buffer_load_dwordx4 v[56:59], v1, s[40:43], s49 offen sc1
    buffer_load_dwordx4 v[60:63], v1, s[40:43], s54 offen sc1
    s_waitcnt vmcnt(2)
    v_xor_b32 v64, s96, v64
    v_xor_b32 v65, s97, v65
    v_xor_b32 v66, s98, v66
    v_xor_b32 v67, s99, v67
    v_xor_b32 v68, s96, v68
    v_xor_b32 v69, s97, v69
    v_xor_b32 v70, s98, v70
    v_xor_b32 v71, s99, v71
    v_or3_b32 v8, v64, v65, v66
    v_or3_b32 v8, v8, v67, v68
    v_or3_b32 v8, v8, v69, v70
    v_or_b32 v8, v8, v71
    v_and_b32 v8, 0xff, v8
    v_cmp_ne_u32 vcc, 0, v8
    s_nop 0
    s_andn2_b64 exec, exec, vcc
    v_mov_b32 v40, v64
    v_mov_b32 v41, v65
    v_mov_b32 v42, v66
    v_mov_b32 v43, v67
    v_mov_b32 v44, v68
    v_mov_b32 v45, v69
    v_mov_b32 v46, v70
    v_mov_b32 v47, v71
    s_mov_b64 exec, vcc
    s_cbranch_vccz L_d49
    buffer_load_dwordx4 v[64:67], v1, s[40:43], s49 offen sc1
    buffer_load_dwordx4 v[68:71], v1, s[40:43], s54 offen sc1
    s_sub_u32 s50, s50, 1
    s_cbranch_scc0 L_poll48
    s_endpgm
L_d49:
    s_mov_b64 exec, -1
    v_pk_add_f32 v[40:41], v[40:41], v[44:45]
    v_pk_add_f32 v[42:43], v[42:43], v[46:47]
    s_nop 1
    v_permlane32_swap_b32 v40, v42
    v_permlane32_swap_b32 v41, v43
    v_pk_add_f32 v[40:41], v[40:41], v[42:43]
    s_nop 1
    v_permlane16_swap_b32 v40, v41
    v_add_f32 v8, v40, v41
    s_nop 1
    v_add_f32_dpp v8, v8, v8 quad_perm:[2,3,0,1] row_mask:0xf bank_mask:0xf
    s_nop 1
    v_add_f32_dpp v8, v8, v8 row_ror:4 row_mask:0xf bank_mask:0xf
    s_nop 1
    v_add_f32_dpp v8, v8, v8 row_ror:8 row_mask:0xf bank_mask:0xf
    v_add_f32 v8, v8, v31
    v_cvt_pk_bf16_f32 v8, v8, v8
    s_mov_b32 exec_lo, 0x30003
    s_mov_b32 exec_hi, 0x30003
    buffer_store_short v8, v30, s[36:39], 0 offen
    s_cmp_lg_u32 s2, 0
    s_cbranch_scc1 L_noep
    s_mov_b64 exec, 1
    buffer_store_dword v29, v6, s[40:43], 0 offen offset:0 sc1
L_noep:
    s_mov_b64 exec, -1
    s_endpgm
L_exit:
    s_endpgm
.section .rodata,"a"
.p2align 6
.amdhsa_kernel parallel_sum__gqa_block_cached__dense_activation_silu__decode_kernel
  .amdhsa_next_free_vgpr 168
  .amdhsa_next_free_sgpr 102
  .amdhsa_accum_offset 168
  .amdhsa_group_segment_fixed_size 0
  .amdhsa_kernarg_size 88
  .amdhsa_user_sgpr_count 2
  .amdhsa_user_sgpr_kernarg_segment_ptr 1
  .amdhsa_system_sgpr_workgroup_id_x 1
  .amdhsa_float_denorm_mode_32 3
.end_amdhsa_kernel
```
